```python
import torch

def _softmax(x, axis=-1):
    return torch.softmax(x, dim=axis)
def _gelu(x):
    return torch.nn.functional.gelu(x, approximate="tanh")
def _silu(x):
    return torch.nn.functional.silu(x)
def _sigmoid(x):
    return torch.sigmoid(x)
def _layernorm(x, axis=-1, eps=1e-5):
    m = x.mean(dim=axis, keepdim=True)
    v = x.var(dim=axis, keepdim=True, unbiased=False)
    return (x - m) / torch.sqrt(v + eps)
def _scatter_add(tgt, idx, src, axis=0):
    return tgt.clone().index_add_(axis, idx, src)
def _segment_sum(src, seg, n):
    out = torch.zeros((n,) + src.shape[1:], dtype=src.dtype)
    return out.index_add_(0, seg, src)
def _pad(x, pw):
    flat = tuple(v for pair in reversed(pw) for v in pair)
    return torch.nn.functional.pad(x, flat)

kernel_name = 'standalone__dense_activation_squared_relu__sampling'

def setup_inputs():

    _w = (lambda a: (lambda t: t.to(torch.bfloat16) if t.is_floating_point() else t)(torch.as_tensor(a)))
    B, S, D, F = 32, 16, 576, 4608
    return {
        "x": _w((lambda *s: torch.randn(*s, dtype=torch.bfloat16) * 0.05)(B, S, D)),
        "w1": _w((lambda *s: torch.randn(*s, dtype=torch.bfloat16) * 0.05)(D, F)),
        "b1": _w((lambda *s: torch.randn(*s, dtype=torch.bfloat16) * 0.05)(F)),
        "w2": _w((lambda *s: torch.randn(*s, dtype=torch.bfloat16) * 0.05)(F, D)),
        "b2": _w((lambda *s: torch.randn(*s, dtype=torch.bfloat16) * 0.05)(D)),
    }

def reference(x, w1, b1, w2, b2):
    h = torch.einsum("bsd,df->bsf", x, w1) + b1
    zero = torch.zeros_like(h)
    r = torch.where(h > zero, h, zero)
    h = r * r
    out = torch.einsum("bsf,fd->bsd", h, w2) + b2
    return out
```

```asm
; @launch grid=(256,1,1) block=(512,1,1) lds=163840
.amdgcn_target "amdgcn-amd-amdhsa--gfx950"
.text
.globl standalone__dense_activation_squared_relu__sampling_kernel
.p2align 8
.type standalone__dense_activation_squared_relu__sampling_kernel,@function
standalone__dense_activation_squared_relu__sampling_kernel:
    s_cmp_ge_u32 s2, 256
    s_cbranch_scc1 L_end
    s_load_dwordx16 s[16:31], s[0:1], 0
    s_lshr_b32 s7, s2, 5
    s_cmp_eq_u32 s7, 6
    s_cbranch_scc1 L_ld2
    v_lshrrev_b32 v1, 6, v0
    v_and_b32 v2, 63, v0
    v_readfirstlane_b32 s69, v1
    s_and_b32 s5, s2, 7
    s_lshr_b32 s6, s2, 3
    s_and_b32 s8, s6, 3
    v_and_b32 v1, 3, v1
    v_lshrrev_b32 v32, 3, v2
    v_lshrrev_b32 v33, 4, v2
    s_and_b32 s9, s69, 3
    s_cmp_lt_u32 s69, 4
    s_cbranch_scc1 L_cpe
    v_and_b32 v34, 7, v2
    v_and_b32 v35, 1, v1
    v_lshl_add_u32 v35, v35, 2, v33
    v_xor_b32 v36, v34, v35
    v_mul_u32_u24 v37, 1152, v32
    v_lshl_add_u32 v3, v36, 4, v37
    v_and_b32 v38, 1, v2
    s_lshl_b32 s14, s9, 10
    s_mov_b32 s34, 589824
    s_mov_b32 s35, 0x20000
    s_mov_b32 s38, 5308416
    s_mov_b32 s39, s35
    s_mul_i32 s4, s5, 1152
    s_min_u32 s7, s7, 6
    v_bfe_u32 v36, v2, 1, 3
    v_xor_b32 v36, v36, v35
    v_lshl_add_u32 v36, v36, 1, v38
    v_lshlrev_b32 v36, 4, v36
    v_mul_u32_u24 v39, 9216, v33
    v_add_u32 v4, v36, v39
    s_mul_i32 s10, s7, 10
    s_add_u32 s10, s10, s9
    s_mul_i32 s10, s10, 9216
    s_lshl_b32 s3, s8, 8
    s_add_u32 s4, s4, s3
    s_mul_i32 s11, s9, 73728
    s_add_u32 s11, s11, s4
    s_mul_i32 s13, s7, 1
    s_cmp_ge_u32 s9, 2
    s_cselect_b64 vcc, -1, 0
    s_lshl_b32 s15, s13, 7
    s_add_u32 s15, s15, s10
    s_mul_i32 s64, s13, 589824
    s_add_u32 s64, s64, s11
    s_add_u32 s13, s13, 1
    s_cmp_eq_u32 s13, 9
    s_cselect_b32 s13, 0, s13
    s_add_u32 m0, s14, 0
    s_waitcnt lgkmcnt(0)
    s_mov_b64 s[32:33], s[16:17]
    s_mov_b64 s[36:37], s[18:19]
    buffer_load_dwordx4 v3, s[32:35], s15 offen lds
    s_add_u32 m0, s14, 10240
    s_nop 0
    buffer_load_dwordx4 v4, s[36:39], s64 offen lds
    s_cbranch_vccnz L_sx0
    s_add_u32 m0, s14, 8192
    s_add_u32 s3, s15, 73728
    buffer_load_dwordx4 v3, s[32:35], s3 offen lds
L_sx0:
    s_add_u32 m0, s14, 14336
    s_add_u32 s3, s64, 36864
    buffer_load_dwordx4 v4, s[36:39], s3 offen lds
    s_add_u32 m0, s14, 4096
    s_add_u32 s3, s15, 36864
    buffer_load_dwordx4 v3, s[32:35], s3 offen lds
    s_add_u32 m0, s14, 18432
    s_add_u32 s3, s64, 294912
    buffer_load_dwordx4 v4, s[36:39], s3 offen lds
    s_add_u32 m0, s14, 22528
    s_add_u32 s3, s64, 331776
    buffer_load_dwordx4 v4, s[36:39], s3 offen lds
    s_lshl_b32 s15, s13, 7
    s_add_u32 s15, s15, s10
    s_mul_i32 s64, s13, 589824
    s_add_u32 s64, s64, s11
    s_add_u32 s13, s13, 1
    s_cmp_eq_u32 s13, 9
    s_cselect_b32 s13, 0, s13
    s_add_u32 m0, s14, 26624
    s_nop 0
    buffer_load_dwordx4 v3, s[32:35], s15 offen lds
    s_add_u32 m0, s14, 36864
    s_nop 0
    buffer_load_dwordx4 v4, s[36:39], s64 offen lds
    s_mov_b64 s[40:41], s[22:23]
    s_mov_b32 s42, s38
    s_mov_b32 s43, s35
    s_mov_b64 s[44:45], s[30:31]
    s_mov_b32 s46, 268435456
    s_mov_b32 s47, s35
    s_mov_b64 s[60:61], s[28:29]
    s_mov_b32 s62, 256
    s_mov_b32 s63, s35
    s_mov_b64 s[48:49], s[26:27]
    s_mov_b32 s50, s34
    s_mov_b32 s51, s35
    v_lshlrev_b32 v40, 3, v33
    s_lshl_b32 s30, s5, 5
    s_cmp_eq_u32 s9, 0
    s_cbranch_scc1 L_rl1a
    v_and_b32 v40, 8, v40
    v_and_or_b32 v40, v2, 32, v40
    s_and_b32 s4, s30, 32
    s_lshr_b32 s4, s4, 1
    s_sub_u32 s30, s30, s4
L_rl1a:
    s_lshl_b32 s4, s8, 8
    s_add_u32 s30, s30, s4
    s_cbranch_vccnz L_ld1b
    s_branch L_seg_l1a
L_seg_h2:
L_cpe:
    s_getpc_b64 s[92:93]
L_pcx0:
    s_lshl_b32 s3, s6, 2
    s_add_u32 s3, s3, s9
    s_mul_i32 s3, s3, 320
    s_min_u32 s3, s3, L_codeend - L_pcx0 - 320
    s_load_dword s94, s[92:93], s3 offset:0
    s_load_dword s94, s[92:93], s3 offset:64
    s_load_dword s94, s[92:93], s3 offset:128
    s_load_dword s94, s[92:93], s3 offset:192
    s_load_dword s94, s[92:93], s3 offset:256
    s_cmp_eq_u32 s7, 6
    s_cbranch_scc1 L_comp2
    s_branch L_comp1
L_ld2:
    v_lshrrev_b32 v1, 6, v0
    v_and_b32 v2, 63, v0
    v_readfirstlane_b32 s69, v1
    s_and_b32 s5, s2, 7
    s_lshr_b32 s6, s2, 3
    s_and_b32 s8, s6, 3
    v_and_b32 v1, 3, v1
    v_lshrrev_b32 v32, 3, v2
    v_lshrrev_b32 v33, 4, v2
    s_and_b32 s9, s69, 3
    s_cmp_lt_u32 s69, 4
    s_cbranch_scc1 L_cpe
    v_and_b32 v34, 7, v2
    v_and_b32 v35, 1, v1
    v_lshl_add_u32 v35, v35, 2, v33
    v_xor_b32 v36, v34, v35
    v_mul_u32_u24 v37, 1152, v32
    v_lshl_add_u32 v3, v36, 4, v37
    v_and_b32 v38, 1, v2
    s_lshl_b32 s14, s9, 10
    s_mov_b32 s34, 589824
    s_mov_b32 s35, 0x20000
    s_mov_b32 s38, 5308416
    s_mov_b32 s39, s35
    s_mul_i32 s4, s5, 1152
    v_bfe_u32 v36, v2, 1, 2
    v_xor_b32 v36, v36, v33
    v_lshl_add_u32 v36, v36, 1, v38
    v_lshlrev_b32 v36, 4, v36
    v_and_b32 v39, 3, v32
    v_lshrrev_b32 v40, 5, v2
    v_lshl_add_u32 v39, v40, 3, v39
    v_mul_u32_u24 v39, 9216, v39
    v_add_u32 v4, v36, v39
    s_lshl_b32 s10, s8, 4
    s_add_u32 s10, s10, s9
    s_mul_i32 s10, s10, 9216
    s_and_b32 s3, s9, 1
    s_lshl_b32 s3, s3, 4
    s_lshr_b32 s11, s9, 1
    s_lshl_b32 s11, s11, 2
    s_add_u32 s11, s11, s3
    s_mul_i32 s11, s11, 9216
    s_add_u32 s11, s11, s4
    s_add_u32 s11, s11, 1024
    s_mul_i32 s13, s8, 2
    s_lshl_b32 s15, s13, 7
    s_add_u32 s15, s15, s10
    s_mul_i32 s64, s13, 589824
    s_add_u32 s64, s64, s11
    s_add_u32 s13, s13, 1
    s_cmp_eq_u32 s13, 9
    s_cselect_b32 s13, 0, s13
    s_add_u32 m0, s14, 0
    s_waitcnt lgkmcnt(0)
    s_mov_b64 s[32:33], s[16:17]
    s_mov_b64 s[36:37], s[18:19]
    buffer_load_dwordx4 v3, s[32:35], s15 offen lds
    s_add_u32 m0, s14, 16384
    s_nop 0
    buffer_load_dwordx4 v4, s[36:39], s64 offen lds
    s_add_u32 m0, s14, 4096
    s_add_u32 s3, s15, 36864
    buffer_load_dwordx4 v3, s[32:35], s3 offen lds
    s_add_u32 m0, s14, 8192
    s_add_u32 s3, s15, 73728
    buffer_load_dwordx4 v3, s[32:35], s3 offen lds
    s_add_u32 m0, s14, 20480
    s_add_u32 s3, s64, 294912
    buffer_load_dwordx4 v4, s[36:39], s3 offen lds
    s_add_u32 m0, s14, 12288
    s_add_u32 s3, s15, 110592
    buffer_load_dwordx4 v3, s[32:35], s3 offen lds
    s_lshl_b32 s15, s13, 7
    s_add_u32 s15, s15, s10
    s_mul_i32 s64, s13, 589824
    s_add_u32 s64, s64, s11
    s_add_u32 s13, s13, 1
    s_cmp_eq_u32 s13, 9
    s_cselect_b32 s13, 0, s13
    s_add_u32 m0, s14, 24576
    s_nop 0
    buffer_load_dwordx4 v3, s[32:35], s15 offen lds
    s_add_u32 m0, s14, 40960
    s_nop 0
    buffer_load_dwordx4 v4, s[36:39], s64 offen lds
    s_add_u32 m0, s14, 28672
    s_add_u32 s3, s15, 36864
    buffer_load_dwordx4 v3, s[32:35], s3 offen lds
    s_branch L_seg_l2
L_pgend0:
.fill (1280 - (L_pgend0 - standalone__dense_activation_squared_relu__sampling_kernel)) / 4, 4, 0xbf800000
L_seg_l1a:
    s_mov_b64 s[56:57], s[24:25]
    s_mov_b32 s58, 1152
    s_mov_b32 s59, 0x20000
    v_lshlrev_b32 v14, 4, v2
    v_mul_u32_u24 v39, 1152, v33
    v_add_u32 v5, v36, v39
    s_mul_i32 s65, s5, 576
    s_lshl_b32 s3, s9, 2
    s_add_u32 s65, s65, s3
    s_add_u32 m0, s14, 34816
    s_add_u32 s3, s15, 73728
    buffer_load_dwordx4 v3, s[32:35], s3 offen lds
    s_add_u32 m0, s14, 40960
    s_add_u32 s3, s64, 36864
    buffer_load_dwordx4 v4, s[36:39], s3 offen lds
    s_add_u32 m0, s14, 30720
    s_add_u32 s3, s15, 36864
    buffer_load_dwordx4 v3, s[32:35], s3 offen lds
    s_add_u32 m0, s14, 45056
    s_add_u32 s3, s64, 294912
    buffer_load_dwordx4 v4, s[36:39], s3 offen lds
    s_add_u32 m0, s14, 49152
    s_add_u32 s3, s64, 331776
    buffer_load_dwordx4 v4, s[36:39], s3 offen lds
    s_lshl_b32 s15, s13, 7
    s_add_u32 s15, s15, s10
    s_mul_i32 s64, s13, 589824
    s_add_u32 s64, s64, s11
    s_add_u32 s13, s13, 1
    s_cmp_eq_u32 s13, 9
    s_cselect_b32 s13, 0, s13
    s_add_u32 m0, s14, 53248
    s_nop 0
    buffer_load_dwordx4 v3, s[32:35], s15 offen lds
    s_add_u32 m0, s14, 63488
    s_waitcnt vmcnt(14)
    buffer_load_dwordx4 v4, s[36:39], s64 offen lds
    s_add_u32 m0, s14, 61440
    s_add_u32 s3, s15, 73728
    s_waitcnt vmcnt(14)
    buffer_load_dwordx4 v3, s[32:35], s3 offen lds
    s_add_u32 m0, s14, 67584
    s_add_u32 s3, s64, 36864
    s_waitcnt vmcnt(14)
    buffer_load_dwordx4 v4, s[36:39], s3 offen lds
    s_add_u32 m0, s14, 57344
    s_add_u32 s3, s15, 36864
    s_waitcnt vmcnt(14)
    buffer_load_dwordx4 v3, s[32:35], s3 offen lds
    s_add_u32 m0, s14, 71680
    s_add_u32 s3, s64, 294912
    s_waitcnt vmcnt(14)
    buffer_load_dwordx4 v4, s[36:39], s3 offen lds
    s_add_u32 m0, s14, 75776
    s_add_u32 s3, s64, 331776
    s_waitcnt vmcnt(14)
    buffer_load_dwordx4 v4, s[36:39], s3 offen lds
    s_lshl_b32 s15, s13, 7
    s_add_u32 s15, s15, s10
    s_mul_i32 s64, s13, 589824
    s_add_u32 s64, s64, s11
    s_add_u32 s13, s13, 1
    s_cmp_eq_u32 s13, 9
    s_cselect_b32 s13, 0, s13
    s_add_u32 m0, s14, 79872
    s_waitcnt vmcnt(14)
    buffer_load_dwordx4 v3, s[32:35], s15 offen lds
    s_barrier
    s_add_u32 m0, s14, 90112
    s_waitcnt vmcnt(14)
    buffer_load_dwordx4 v4, s[36:39], s64 offen lds
    s_add_u32 m0, s14, 88064
    s_add_u32 s3, s15, 73728
    s_waitcnt vmcnt(14)
    buffer_load_dwordx4 v3, s[32:35], s3 offen lds
    s_add_u32 m0, s14, 94208
    s_add_u32 s3, s64, 36864
    s_waitcnt vmcnt(14)
    buffer_load_dwordx4 v4, s[36:39], s3 offen lds
    s_add_u32 m0, s14, 83968
    s_add_u32 s3, s15, 36864
    s_waitcnt vmcnt(14)
    buffer_load_dwordx4 v3, s[32:35], s3 offen lds
    s_add_u32 m0, s14, 98304
    s_add_u32 s3, s64, 294912
    s_waitcnt vmcnt(14)
    buffer_load_dwordx4 v4, s[36:39], s3 offen lds
    s_add_u32 m0, s14, 102400
    s_add_u32 s3, s64, 331776
    s_waitcnt vmcnt(14)
    buffer_load_dwordx4 v4, s[36:39], s3 offen lds
    s_load_dword s68, s[60:61], 0
    s_mul_i32 s65, s65, 1152
    s_lshl_b32 s3, s8, 8
    s_add_u32 s65, s65, s3
    s_and_b32 s66, s7, 1
    s_lshl_b32 s67, s8, 1
    s_add_u32 s16, s67, s66
    s_xor_b32 s17, s16, 1
    s_mul_i32 s3, s7, 1
    s_lshr_b32 s3, s3, 1
    s_mul_i32 s4, s3, 86
    s_lshr_b32 s4, s4, 8
    s_mul_i32 s4, s4, 3
    s_sub_u32 s3, s3, s4
    s_add_u32 s4, s3, 1
    s_lshl_b32 s4, s4, 1
    s_xor_b32 s18, s16, s4
    s_xor_b32 s19, s18, 1
    s_add_u32 s3, s3, 1
    s_cmp_eq_u32 s3, 3
    s_cselect_b32 s3, 0, s3
    s_add_u32 s4, s3, 1
    s_lshl_b32 s4, s4, 1
    s_xor_b32 s20, s16, s4
    s_xor_b32 s21, s20, 1
    s_add_u32 s3, s3, 1
    s_cmp_eq_u32 s3, 3
    s_cselect_b32 s3, 0, s3
    s_add_u32 s4, s3, 1
    s_lshl_b32 s4, s4, 1
    s_xor_b32 s22, s16, s4
    s_waitcnt vmcnt(14)
    s_barrier
    s_lshl_b32 s15, s13, 7
    s_add_u32 s15, s15, s10
    s_mul_i32 s64, s13, 589824
    s_add_u32 s64, s64, s11
    s_add_u32 s13, s13, 1
    s_cmp_eq_u32 s13, 9
    s_cselect_b32 s13, 0, s13
    s_add_u32 m0, s14, 0
    s_nop 0
    buffer_load_dwordx4 v3, s[32:35], s15 offen lds
    s_add_u32 m0, s14, 10240
    s_waitcnt vmcnt(14)
    buffer_load_dwordx4 v4, s[36:39], s64 offen lds
    s_add_u32 m0, s14, 8192
    s_add_u32 s3, s15, 73728
    s_waitcnt vmcnt(14)
    buffer_load_dwordx4 v3, s[32:35], s3 offen lds
    s_add_u32 m0, s14, 14336
    s_add_u32 s3, s64, 36864
    s_waitcnt vmcnt(14)
    buffer_load_dwordx4 v4, s[36:39], s3 offen lds
    s_add_u32 m0, s14, 4096
    s_add_u32 s3, s15, 36864
    s_waitcnt vmcnt(14)
    buffer_load_dwordx4 v3, s[32:35], s3 offen lds
    s_add_u32 m0, s14, 18432
    s_add_u32 s3, s64, 294912
    s_waitcnt vmcnt(14)
    buffer_load_dwordx4 v4, s[36:39], s3 offen lds
    s_add_u32 m0, s14, 22528
    s_add_u32 s3, s64, 331776
    s_waitcnt vmcnt(14)
    buffer_load_dwordx4 v4, s[36:39], s3 offen lds
    s_xor_b32 s23, s22, 1
    s_mov_b32 s24, 8
    s_mul_i32 s12, s7, 5
    s_cmp_eq_u32 s7, 6
    s_cselect_b32 s3, 0x7fff0000, 0
    v_mov_b32 v6, v14
    v_add_u32 v7, 1024, v14
    v_add_u32 v13, s3, v14
    s_waitcnt vmcnt(14)
    s_barrier
    s_lshl_b32 s15, s13, 7
    s_add_u32 s15, s15, s10
    s_mul_i32 s64, s13, 589824
    s_add_u32 s64, s64, s11
    s_add_u32 s13, s13, 1
    s_cmp_eq_u32 s13, 9
    s_cselect_b32 s13, 0, s13
    s_add_u32 m0, s14, 26624
    s_nop 0
    buffer_load_dwordx4 v3, s[32:35], s15 offen lds
    s_add_u32 m0, s14, 36864
    s_waitcnt vmcnt(14)
    buffer_load_dwordx4 v4, s[36:39], s64 offen lds
    s_add_u32 m0, s14, 34816
    s_add_u32 s3, s15, 73728
    s_waitcnt vmcnt(14)
    buffer_load_dwordx4 v3, s[32:35], s3 offen lds
    s_add_u32 m0, s14, 40960
    s_add_u32 s3, s64, 36864
    s_waitcnt vmcnt(14)
    buffer_load_dwordx4 v4, s[36:39], s3 offen lds
    s_add_u32 m0, s14, 30720
    s_add_u32 s3, s15, 36864
    s_waitcnt vmcnt(14)
    buffer_load_dwordx4 v3, s[32:35], s3 offen lds
    s_add_u32 m0, s14, 45056
    s_add_u32 s3, s64, 294912
    s_waitcnt vmcnt(14)
    buffer_load_dwordx4 v4, s[36:39], s3 offen lds
    s_add_u32 m0, s14, 49152
    s_add_u32 s3, s64, 331776
    s_waitcnt vmcnt(14)
    buffer_load_dwordx4 v4, s[36:39], s3 offen lds
    v_add_u32 v8, 2048, v13
    v_add_u32 v9, 3072, v13
    v_add_u32 v13, 4096, v13
    s_and_b32 s3, s9, 1
    s_lshl_b32 s31, s3, 10
    s_mov_b32 s27, s12
    s_mul_i32 s28, s5, 622592
    s_add_u32 s28, s28, 17367040
    s_add_u32 s29, s28, 16384
    s_add_u32 s52, s44, s28
    s_addc_u32 s53, s45, 0
    s_mov_b32 s25, 0
    s_lshl_b32 s3, s3, 5
    s_add_u32 s12, s12, s3
    s_lshl_b32 s12, s12, 10
    s_mul_i32 s3, s5, 622592
    s_add_u32 s12, s12, s3
    s_add_u32 s12, s12, 16777216
    s_lshl_b32 s3, s18, 16
    s_add_u32 s94, s3, s12
    s_waitcnt vmcnt(14)
    s_barrier
    s_lshl_b32 s15, s13, 7
    s_add_u32 s15, s15, s10
    s_mul_i32 s64, s13, 589824
    s_add_u32 s64, s64, s11
    s_add_u32 s13, s13, 1
    s_cmp_eq_u32 s13, 9
    s_cselect_b32 s13, 0, s13
    s_add_u32 m0, s14, 53248
    s_nop 0
    buffer_load_dwordx4 v3, s[32:35], s15 offen lds
    s_add_u32 m0, s14, 63488
    s_waitcnt vmcnt(14)
    buffer_load_dwordx4 v4, s[36:39], s64 offen lds
    s_add_u32 m0, s14, 61440
    s_add_u32 s3, s15, 73728
    s_waitcnt vmcnt(14)
    buffer_load_dwordx4 v3, s[32:35], s3 offen lds
    s_add_u32 m0, s14, 67584
    s_add_u32 s3, s64, 36864
    s_waitcnt vmcnt(14)
    buffer_load_dwordx4 v4, s[36:39], s3 offen lds
    s_add_u32 m0, s14, 57344
    s_add_u32 s3, s15, 36864
    s_waitcnt vmcnt(14)
    buffer_load_dwordx4 v3, s[32:35], s3 offen lds
    s_add_u32 m0, s14, 71680
    s_add_u32 s3, s64, 294912
    s_waitcnt vmcnt(14)
    buffer_load_dwordx4 v4, s[36:39], s3 offen lds
    s_add_u32 m0, s14, 75776
    s_add_u32 s3, s64, 331776
    s_waitcnt vmcnt(14)
    buffer_load_dwordx4 v4, s[36:39], s3 offen lds
    s_lshl_b32 s3, s19, 16
    s_add_u32 s95, s3, s12
    s_lshl_b32 s3, s20, 16
    s_add_u32 s96, s3, s12
    s_lshl_b32 s3, s21, 16
    s_add_u32 s97, s3, s12
    s_lshl_b32 s3, s22, 16
    s_add_u32 s98, s3, s12
    s_lshl_b32 s3, s23, 16
    s_add_u32 s99, s3, s12
    s_lshl_b32 s3, s24, 16
    s_add_u32 s100, s3, s12
    s_getreg_b32 s67, hwreg(HW_REG_XCC_ID, 0, 4)
    s_lshl_b32 s67, s67, 28
    s_mov_b32 s69, 0
    buffer_load_dwordx2 v[46:47], v40, s[56:59], s30 offen
    s_waitcnt vmcnt(15)
    s_barrier
    s_lshl_b32 s15, s13, 7
    s_add_u32 s15, s15, s10
    s_mul_i32 s64, s13, 589824
    s_add_u32 s64, s64, s11
    s_add_u32 s13, s13, 1
    s_cmp_eq_u32 s13, 9
    s_cselect_b32 s13, 0, s13
    s_add_u32 m0, s14, 79872
    s_waitcnt vmcnt(14)
    buffer_load_dwordx4 v3, s[32:35], s15 offen lds
    s_add_u32 m0, s14, 90112
    s_waitcnt vmcnt(14)
    buffer_load_dwordx4 v4, s[36:39], s64 offen lds
    s_add_u32 m0, s14, 88064
    s_add_u32 s3, s15, 73728
    s_waitcnt vmcnt(14)
    buffer_load_dwordx4 v3, s[32:35], s3 offen lds
    s_add_u32 m0, s14, 94208
    s_add_u32 s3, s64, 36864
    s_waitcnt vmcnt(14)
    buffer_load_dwordx4 v4, s[36:39], s3 offen lds
    s_add_u32 m0, s14, 83968
    s_add_u32 s3, s15, 36864
    s_waitcnt vmcnt(14)
    buffer_load_dwordx4 v3, s[32:35], s3 offen lds
    s_add_u32 m0, s14, 98304
    s_add_u32 s3, s64, 294912
    s_waitcnt vmcnt(14)
    buffer_load_dwordx4 v4, s[36:39], s3 offen lds
    s_add_u32 m0, s14, 102400
    s_add_u32 s3, s64, 331776
    s_waitcnt vmcnt(14)
    buffer_load_dwordx4 v4, s[36:39], s3 offen lds
    s_barrier
    s_lshl_b32 s15, s13, 7
    s_add_u32 s15, s15, s10
    s_mul_i32 s64, s13, 589824
    s_add_u32 s64, s64, s11
    s_add_u32 m0, s14, 0
    s_waitcnt vmcnt(14)
    buffer_load_dwordx4 v3, s[32:35], s15 offen lds
    s_add_u32 m0, s14, 10240
    s_waitcnt vmcnt(14)
    buffer_load_dwordx4 v4, s[36:39], s64 offen lds
    s_add_u32 m0, s14, 8192
    s_add_u32 s3, s15, 73728
    s_waitcnt vmcnt(14)
    buffer_load_dwordx4 v3, s[32:35], s3 offen lds
    s_add_u32 m0, s14, 14336
    s_add_u32 s3, s64, 36864
    s_waitcnt vmcnt(14)
    buffer_load_dwordx4 v4, s[36:39], s3 offen lds
    s_add_u32 m0, s14, 4096
    s_add_u32 s3, s15, 36864
    s_waitcnt vmcnt(14)
    buffer_load_dwordx4 v3, s[32:35], s3 offen lds
    s_add_u32 m0, s14, 18432
    s_add_u32 s3, s64, 294912
    s_waitcnt vmcnt(14)
    buffer_load_dwordx4 v4, s[36:39], s3 offen lds
    s_add_u32 m0, s14, 22528
    s_add_u32 s3, s64, 331776
    s_waitcnt vmcnt(14)
    buffer_load_dwordx4 v4, s[36:39], s3 offen lds
    s_barrier
    s_mul_i32 s64, s16, 73728
    s_add_u32 s64, s64, s65
    s_add_u32 m0, s14, 106496
    s_waitcnt vmcnt(14)
    buffer_load_dwordx4 v5, s[40:43], s64 offen lds
    s_add_u32 m0, s14, 110592
    s_add_u32 s3, s64, 18432
    s_waitcnt vmcnt(14)
    buffer_load_dwordx4 v5, s[40:43], s3 offen lds
    s_add_u32 m0, s14, 114688
    s_add_u32 s3, s64, 36864
    s_waitcnt vmcnt(14)
    buffer_load_dwordx4 v5, s[40:43], s3 offen lds
    s_add_u32 m0, s14, 118784
    s_add_u32 s3, s64, 55296
    s_waitcnt vmcnt(14)
    buffer_load_dwordx4 v5, s[40:43], s3 offen lds
    s_mul_i32 s64, s18, 73728
    s_add_u32 s64, s64, s65
    s_add_u32 m0, s14, 139264
    s_waitcnt vmcnt(14)
    buffer_load_dwordx4 v5, s[40:43], s64 offen lds
    s_add_u32 m0, s14, 143360
    s_add_u32 s3, s64, 18432
    s_waitcnt vmcnt(14)
    buffer_load_dwordx4 v5, s[40:43], s3 offen lds
    s_add_u32 m0, s14, 147456
    s_add_u32 s3, s64, 36864
    s_waitcnt vmcnt(14)
    buffer_load_dwordx4 v5, s[40:43], s3 offen lds
    s_add_u32 m0, s14, 151552
    s_add_u32 s3, s64, 55296
    s_waitcnt vmcnt(14)
    buffer_load_dwordx4 v5, s[40:43], s3 offen lds
    s_barrier
    s_mul_i32 s64, s17, 73728
    s_add_u32 s64, s64, s65
    s_add_u32 m0, s14, 122880
    s_waitcnt vmcnt(14)
    buffer_load_dwordx4 v5, s[40:43], s64 offen lds
    s_add_u32 m0, s14, 126976
    s_add_u32 s3, s64, 18432
    s_waitcnt vmcnt(14)
    buffer_load_dwordx4 v5, s[40:43], s3 offen lds
    s_add_u32 m0, s14, 131072
    s_add_u32 s3, s64, 36864
    s_waitcnt vmcnt(14)
    buffer_load_dwordx4 v5, s[40:43], s3 offen lds
    s_add_u32 m0, s14, 135168
    s_add_u32 s3, s64, 55296
    s_waitcnt vmcnt(14)
    buffer_load_dwordx4 v5, s[40:43], s3 offen lds
    s_waitcnt vmcnt(12)
    s_barrier
    s_and_b32 s3, s9, 1
    s_lshl_b32 s3, s3, 5
    s_lshl_b32 s4, s7, 6
    s_lshl_b32 s66, s8, 3
    s_add_u32 s66, s66, s4
    s_add_u32 s12, s4, s3
    s_and_b32 s10, s18, 6
    s_and_b32 s11, s20, 6
    s_and_b32 s13, s22, 6
    s_lshr_b32 s15, s27, 2
    s_min_u32 s15, s15, 6
    s_lshl_b32 s15, s15, 2
    s_add_u32 s15, s15, s3
    s_add_u32 s15, s15, 448
    s_waitcnt lgkmcnt(0)
    s_cmp_eq_u32 s68, 0
    s_cbranch_scc1 L_nr1a
L_nok1a:
    v_mov_b32 v41, s68
    s_xor_b32 s67, s67, s68
    s_mov_b64 s[68:69], 0
    s_mov_b32 s54, s67
    s_mov_b32 s55, s67
    s_mov_b64 s[32:33], 0
    s_mov_b64 s[34:35], 0
    s_mov_b64 s[36:37], 0
    s_mov_b64 s[38:39], 0
    s_mov_b64 s[56:57], 0
    s_mov_b64 s[58:59], 0
    s_mov_b64 s[60:61], 0
    s_mov_b64 s[62:63], 0
    s_mov_b64 s[26:27], 0
    s_mul_i32 s64, s19, 73728
    s_add_u32 s64, s64, s65
    s_add_u32 m0, s14, 26624
    s_waitcnt vmcnt(7)
    buffer_load_dwordx4 v5, s[40:43], s64 offen lds
    s_add_u32 m0, s14, 30720
    s_add_u32 s3, s64, 18432
    s_waitcnt vmcnt(7)
    buffer_load_dwordx4 v5, s[40:43], s3 offen lds
    s_add_u32 m0, s14, 34816
    s_add_u32 s3, s64, 36864
    s_waitcnt vmcnt(7)
    buffer_load_dwordx4 v5, s[40:43], s3 offen lds
    s_add_u32 m0, s14, 38912
    s_add_u32 s3, s64, 55296
    s_waitcnt vmcnt(7)
    buffer_load_dwordx4 v5, s[40:43], s3 offen lds
    s_mul_i32 s64, s20, 73728
    s_add_u32 s64, s64, s65
    s_add_u32 m0, s14, 53248
    s_waitcnt vmcnt(7)
    buffer_load_dwordx4 v5, s[40:43], s64 offen lds
    s_add_u32 m0, s14, 57344
    s_add_u32 s3, s64, 18432
    s_waitcnt vmcnt(7)
    buffer_load_dwordx4 v5, s[40:43], s3 offen lds
    s_add_u32 m0, s14, 61440
    s_add_u32 s3, s64, 36864
    s_waitcnt vmcnt(7)
    buffer_load_dwordx4 v5, s[40:43], s3 offen lds
    s_add_u32 m0, s14, 65536
    s_add_u32 s3, s64, 55296
    s_waitcnt vmcnt(7)
    buffer_load_dwordx4 v5, s[40:43], s3 offen lds
    s_cmp_lg_u32 s7, 6
    s_cbranch_scc1 L_nj1a
    s_mul_i32 s64, s24, 73728
    s_add_u32 s64, s64, s65
    s_add_u32 m0, s14, 47104
    s_nop 0
    buffer_load_dwordx4 v5, s[40:43], s64 offen lds
    s_add_u32 m0, s14, 47104
    s_add_u32 s3, s64, 18432
    buffer_load_dwordx4 v5, s[40:43], s3 offen lds
    s_add_u32 m0, s14, 47104
    s_add_u32 s3, s64, 36864
    buffer_load_dwordx4 v5, s[40:43], s3 offen lds
    s_add_u32 m0, s14, 47104
    s_add_u32 s3, s64, 55296
    buffer_load_dwordx4 v5, s[40:43], s3 offen lds
L_nj1a:
    s_barrier
    s_mul_i32 s64, s21, 73728
    s_add_u32 s64, s64, s65
    s_add_u32 m0, s14, 79872
    s_waitcnt vmcnt(7)
    buffer_load_dwordx4 v5, s[40:43], s64 offen lds
    s_add_u32 m0, s14, 83968
    s_add_u32 s3, s64, 18432
    s_waitcnt vmcnt(7)
    buffer_load_dwordx4 v5, s[40:43], s3 offen lds
    s_add_u32 m0, s14, 88064
    s_add_u32 s3, s64, 36864
    s_waitcnt vmcnt(7)
    buffer_load_dwordx4 v5, s[40:43], s3 offen lds
    s_add_u32 m0, s14, 92160
    s_add_u32 s3, s64, 55296
    s_waitcnt vmcnt(7)
    buffer_load_dwordx4 v5, s[40:43], s3 offen lds
    s_barrier
    s_mov_b32 m0, s10
    s_branch L_g1a_a11
L_q1a_a11:
    s_add_u32 s68, s68, 1
    s_cmp_gt_u32 s68, 15
    s_cbranch_scc1 L_c1a_a11
    s_load_dwordx8 s[32:39], s[52:53], s12 offset:512
    s_add_u32 s52, s52, 1024
    s_addc_u32 s53, s53, 0
    s_waitcnt lgkmcnt(0)
L_g1a_a11:
    s_movrels_b64 vcc, s[32:33]
    s_cmp_lg_u64 vcc, s[54:55]
    s_cbranch_scc1 L_q1a_a11
    s_add_u32 m0, s31, 155648
    s_nop 0
    buffer_load_dwordx4 v6, s[44:47], s94 offen sc1 lds
    s_add_u32 m0, s31, 157696
    s_nop 0
    buffer_load_dwordx4 v7, s[44:47], s94 offen sc1 lds
    s_add_u32 m0, s31, 159744
    s_nop 0
    buffer_load_dwordx4 v6, s[44:47], s95 offen sc1 lds
    s_add_u32 m0, s31, 161792
    s_nop 0
    buffer_load_dwordx4 v7, s[44:47], s95 offen sc1 lds
    s_mov_b32 m0, s11
    s_branch L_g1a_a13
L_q1a_a13:
    s_add_u32 s68, s68, 1
    s_cmp_gt_u32 s68, 15
    s_cbranch_scc1 L_c1a_a13
    s_load_dwordx8 s[32:39], s[52:53], s12 offset:512
    s_add_u32 s52, s52, 1024
    s_addc_u32 s53, s53, 0
    s_waitcnt lgkmcnt(0)
L_g1a_a13:
    s_movrels_b64 vcc, s[32:33]
    s_cmp_lg_u64 vcc, s[54:55]
    s_cbranch_scc1 L_q1a_a13
    s_add_u32 m0, s31, 96256
    s_nop 0
    buffer_load_dwordx4 v6, s[44:47], s96 offen sc1 lds
    s_add_u32 m0, s31, 98304
    s_nop 0
    buffer_load_dwordx4 v7, s[44:47], s96 offen sc1 lds
    s_add_u32 m0, s31, 100352
    s_nop 0
    buffer_load_dwordx4 v6, s[44:47], s97 offen sc1 lds
    s_add_u32 m0, s31, 102400
    s_waitcnt vmcnt(14)
    buffer_load_dwordx4 v7, s[44:47], s97 offen sc1 lds
    s_mov_b32 m0, s13
    s_branch L_g1a_a15
L_q1a_a15:
    s_add_u32 s68, s68, 1
    s_cmp_gt_u32 s68, 15
    s_cbranch_scc1 L_c1a_a15
    s_load_dwordx8 s[32:39], s[52:53], s12 offset:512
    s_add_u32 s52, s52, 1024
    s_addc_u32 s53, s53, 0
    s_waitcnt lgkmcnt(0)
L_g1a_a15:
    s_movrels_b64 vcc, s[32:33]
    s_cmp_lg_u64 vcc, s[54:55]
    s_cbranch_scc1 L_q1a_a15
    s_add_u32 m0, s31, 104448
    s_waitcnt vmcnt(14)
    buffer_load_dwordx4 v6, s[44:47], s98 offen sc1 lds
    s_add_u32 m0, s31, 16384
    s_waitcnt vmcnt(14)
    buffer_load_dwordx4 v7, s[44:47], s98 offen sc1 lds
    s_add_u32 m0, s31, 18432
    s_waitcnt vmcnt(14)
    buffer_load_dwordx4 v6, s[44:47], s99 offen sc1 lds
    s_add_u32 m0, s31, 20480
    s_waitcnt vmcnt(14)
    buffer_load_dwordx4 v7, s[44:47], s99 offen sc1 lds
    s_add_u32 s68, s68, 1
    s_cmp_gt_u32 s68, 15
    s_cbranch_scc1 L_c1a_r10b
    s_load_dwordx8 s[56:63], s[52:53], s12
    s_load_dwordx2 s[26:27], s[52:53], s15
    s_add_u32 s52, s52, 1024
    s_addc_u32 s53, s53, 0
    s_waitcnt lgkmcnt(0)
L_r1a_10b:
    s_waitcnt vmcnt(8)
    s_barrier
    s_branch L_g1a_a17
L_q1a_a17:
    s_add_u32 s68, s68, 1
    s_cmp_gt_u32 s68, 15
    s_cbranch_scc1 L_c1a_a17
    s_load_dwordx8 s[56:63], s[52:53], s12
    s_load_dwordx2 s[26:27], s[52:53], s15
    s_add_u32 s52, s52, 1024
    s_addc_u32 s53, s53, 0
    s_waitcnt lgkmcnt(0)
L_g1a_a17:
    s_cmp_lg_u64 s[26:27], s[54:55]
    s_cbranch_scc1 L_q1a_a17
    s_add_u32 m0, s31, 22528
    s_nop 0
    buffer_load_dwordx4 v6, s[44:47], s100 offen sc1 lds
    s_add_u32 m0, s31, 24576
    s_nop 0
    buffer_load_dwordx4 v7, s[44:47], s100 offen sc1 lds
    s_mov_b32 m0, s10
    s_branch L_g1a_d11
L_q1a_d11:
    s_add_u32 s68, s68, 1
    s_cmp_gt_u32 s68, 15
    s_cbranch_scc1 L_c1a_d11
    s_load_dwordx8 s[56:63], s[52:53], s12
    s_load_dwordx2 s[26:27], s[52:53], s15
    s_add_u32 s52, s52, 1024
    s_addc_u32 s53, s53, 0
    s_waitcnt lgkmcnt(0)
L_g1a_d11:
    s_movrels_b64 vcc, s[56:57]
    s_cmp_lg_u64 vcc, s[54:55]
    s_cbranch_scc1 L_q1a_d11
    s_add_u32 m0, s31, 43008
    s_nop 0
    buffer_load_dwordx4 v8, s[44:47], s94 offen sc1 lds
    s_add_u32 m0, s31, 45056
    s_nop 0
    buffer_load_dwordx4 v8, s[44:47], s95 offen sc1 lds
    s_mov_b32 m0, s11
    s_branch L_g1a_d13
L_q1a_d13:
    s_add_u32 s68, s68, 1
    s_cmp_gt_u32 s68, 15
    s_cbranch_scc1 L_c1a_d13
    s_load_dwordx8 s[56:63], s[52:53], s12
    s_load_dwordx2 s[26:27], s[52:53], s15
    s_add_u32 s52, s52, 1024
    s_addc_u32 s53, s53, 0
    s_waitcnt lgkmcnt(0)
L_g1a_d13:
    s_movrels_b64 vcc, s[56:57]
    s_cmp_lg_u64 vcc, s[54:55]
    s_cbranch_scc1 L_q1a_d13
    s_add_u32 m0, s31, 47104
    s_nop 0
    buffer_load_dwordx4 v8, s[44:47], s96 offen sc1 lds
    s_add_u32 m0, s31, 49152
    s_nop 0
    buffer_load_dwordx4 v8, s[44:47], s97 offen sc1 lds
    s_waitcnt vmcnt(10)
    s_barrier
    s_mov_b32 m0, s13
    s_branch L_g1a_d15
L_q1a_d15:
    s_add_u32 s68, s68, 1
    s_cmp_gt_u32 s68, 15
    s_cbranch_scc1 L_c1a_d15
    s_load_dwordx8 s[56:63], s[52:53], s12
    s_load_dwordx2 s[26:27], s[52:53], s15
    s_add_u32 s52, s52, 1024
    s_addc_u32 s53, s53, 0
    s_waitcnt lgkmcnt(0)
L_g1a_d15:
    s_movrels_b64 vcc, s[56:57]
    s_cmp_lg_u64 vcc, s[54:55]
    s_cbranch_scc1 L_q1a_d15
    s_add_u32 m0, s31, 51200
    s_nop 0
    buffer_load_dwordx4 v8, s[44:47], s98 offen sc1 lds
    s_add_u32 m0, s31, 69632
    s_nop 0
    buffer_load_dwordx4 v8, s[44:47], s99 offen sc1 lds
    s_add_u32 m0, s31, 71680
    s_nop 0
    buffer_load_dwordx4 v8, s[44:47], s100 offen sc1 lds
    s_add_u32 m0, s31, 73728
    s_nop 0
    buffer_load_dwordx4 v9, s[44:47], s94 offen sc1 lds
    s_waitcnt vmcnt(10)
    s_barrier
    s_add_u32 m0, s31, 77824
    s_nop 0
    buffer_load_dwordx4 v9, s[44:47], s96 offen sc1 lds
    s_add_u32 m0, s31, 141312
    s_nop 0
    buffer_load_dwordx4 v9, s[44:47], s98 offen sc1 lds
    s_add_u32 m0, s31, 145408
    s_nop 0
    buffer_load_dwordx4 v9, s[44:47], s100 offen sc1 lds
    s_add_u32 m0, s31, 147456
    s_nop 0
    buffer_load_dwordx4 v13, s[44:47], s94 offen sc1 lds
    s_add_u32 m0, s31, 151552
    s_nop 0
    buffer_load_dwordx4 v13, s[44:47], s96 offen sc1 lds
    s_add_u32 m0, s31, 26624
    s_waitcnt vmcnt(14)
    buffer_load_dwordx4 v13, s[44:47], s98 offen sc1 lds
    s_add_u32 m0, s31, 30720
    s_waitcnt vmcnt(14)
    buffer_load_dwordx4 v13, s[44:47], s100 offen sc1 lds
    s_waitcnt vmcnt(11)
    s_barrier
    s_cmp_eq_u32 s7, 6
    s_cbranch_scc1 L_lx1a
    s_waitcnt vmcnt(4)
    s_barrier
    s_branch L_seg_f1a
L_pgend1:
.fill (5376 - (L_pgend1 - standalone__dense_activation_squared_relu__sampling_kernel)) / 4, 4, 0xbf800000
L_seg_l1b:
L_ld1b:
    s_mov_b64 s[56:57], s[24:25]
    s_mov_b32 s58, 1152
    s_mov_b32 s59, 0x20000
    v_lshlrev_b32 v14, 4, v2
    v_mul_u32_u24 v39, 1152, v33
    v_add_u32 v5, v36, v39
    s_mul_i32 s65, s5, 576
    s_lshl_b32 s3, s9, 2
    s_add_u32 s65, s65, s3
    s_add_u32 m0, s14, 40960
    s_add_u32 s3, s64, 36864
    buffer_load_dwordx4 v4, s[36:39], s3 offen lds
    s_add_u32 m0, s14, 30720
    s_add_u32 s3, s15, 36864
    buffer_load_dwordx4 v3, s[32:35], s3 offen lds
    s_add_u32 m0, s14, 45056
    s_add_u32 s3, s64, 294912
    buffer_load_dwordx4 v4, s[36:39], s3 offen lds
    s_add_u32 m0, s14, 49152
    s_add_u32 s3, s64, 331776
    buffer_load_dwordx4 v4, s[36:39], s3 offen lds
    s_lshl_b32 s15, s13, 7
    s_add_u32 s15, s15, s10
    s_mul_i32 s64, s13, 589824
    s_add_u32 s64, s64, s11
    s_add_u32 s13, s13, 1
    s_cmp_eq_u32 s13, 9
    s_cselect_b32 s13, 0, s13
    s_add_u32 m0, s14, 53248
    s_nop 0
    buffer_load_dwordx4 v3, s[32:35], s15 offen lds
    s_add_u32 m0, s14, 63488
    s_waitcnt vmcnt(12)
    buffer_load_dwordx4 v4, s[36:39], s64 offen lds
    s_add_u32 m0, s14, 67584
    s_add_u32 s3, s64, 36864
    s_waitcnt vmcnt(12)
    buffer_load_dwordx4 v4, s[36:39], s3 offen lds
    s_add_u32 m0, s14, 57344
    s_add_u32 s3, s15, 36864
    s_waitcnt vmcnt(12)
    buffer_load_dwordx4 v3, s[32:35], s3 offen lds
    s_add_u32 m0, s14, 71680
    s_add_u32 s3, s64, 294912
    s_waitcnt vmcnt(12)
    buffer_load_dwordx4 v4, s[36:39], s3 offen lds
    s_add_u32 m0, s14, 75776
    s_add_u32 s3, s64, 331776
    s_waitcnt vmcnt(12)
    buffer_load_dwordx4 v4, s[36:39], s3 offen lds
    s_lshl_b32 s15, s13, 7
    s_add_u32 s15, s15, s10
    s_mul_i32 s64, s13, 589824
    s_add_u32 s64, s64, s11
    s_add_u32 s13, s13, 1
    s_cmp_eq_u32 s13, 9
    s_cselect_b32 s13, 0, s13
    s_add_u32 m0, s14, 79872
    s_waitcnt vmcnt(12)
    buffer_load_dwordx4 v3, s[32:35], s15 offen lds
    s_barrier
    s_add_u32 m0, s14, 90112
    s_waitcnt vmcnt(12)
    buffer_load_dwordx4 v4, s[36:39], s64 offen lds
    s_add_u32 m0, s14, 94208
    s_add_u32 s3, s64, 36864
    s_waitcnt vmcnt(12)
    buffer_load_dwordx4 v4, s[36:39], s3 offen lds
    s_add_u32 m0, s14, 83968
    s_add_u32 s3, s15, 36864
    s_waitcnt vmcnt(12)
    buffer_load_dwordx4 v3, s[32:35], s3 offen lds
    s_add_u32 m0, s14, 98304
    s_add_u32 s3, s64, 294912
    s_waitcnt vmcnt(12)
    buffer_load_dwordx4 v4, s[36:39], s3 offen lds
    s_add_u32 m0, s14, 102400
    s_add_u32 s3, s64, 331776
    s_waitcnt vmcnt(12)
    buffer_load_dwordx4 v4, s[36:39], s3 offen lds
    s_load_dword s68, s[60:61], 0
    s_mul_i32 s65, s65, 1152
    s_lshl_b32 s3, s8, 8
    s_add_u32 s65, s65, s3
    s_and_b32 s66, s7, 1
    s_lshl_b32 s67, s8, 1
    s_add_u32 s16, s67, s66
    s_xor_b32 s17, s16, 1
    s_mul_i32 s3, s7, 1
    s_lshr_b32 s3, s3, 1
    s_mul_i32 s4, s3, 86
    s_lshr_b32 s4, s4, 8
    s_mul_i32 s4, s4, 3
    s_sub_u32 s3, s3, s4
    s_add_u32 s4, s3, 1
    s_lshl_b32 s4, s4, 1
    s_xor_b32 s18, s16, s4
    s_xor_b32 s19, s18, 1
    s_add_u32 s3, s3, 1
    s_cmp_eq_u32 s3, 3
    s_cselect_b32 s3, 0, s3
    s_add_u32 s4, s3, 1
    s_lshl_b32 s4, s4, 1
    s_xor_b32 s20, s16, s4
    s_xor_b32 s21, s20, 1
    s_add_u32 s3, s3, 1
    s_cmp_eq_u32 s3, 3
    s_cselect_b32 s3, 0, s3
    s_add_u32 s4, s3, 1
    s_lshl_b32 s4, s4, 1
    s_xor_b32 s22, s16, s4
    s_waitcnt vmcnt(12)
    s_barrier
    s_lshl_b32 s15, s13, 7
    s_add_u32 s15, s15, s10
    s_mul_i32 s64, s13, 589824
    s_add_u32 s64, s64, s11
    s_add_u32 s13, s13, 1
    s_cmp_eq_u32 s13, 9
    s_cselect_b32 s13, 0, s13
    s_add_u32 m0, s14, 0
    s_nop 0
    buffer_load_dwordx4 v3, s[32:35], s15 offen lds
    s_add_u32 m0, s14, 10240
    s_waitcnt vmcnt(12)
    buffer_load_dwordx4 v4, s[36:39], s64 offen lds
    s_add_u32 m0, s14, 14336
    s_add_u32 s3, s64, 36864
    s_waitcnt vmcnt(12)
    buffer_load_dwordx4 v4, s[36:39], s3 offen lds
    s_add_u32 m0, s14, 4096
    s_add_u32 s3, s15, 36864
    s_waitcnt vmcnt(12)
    buffer_load_dwordx4 v3, s[32:35], s3 offen lds
    s_add_u32 m0, s14, 18432
    s_add_u32 s3, s64, 294912
    s_waitcnt vmcnt(12)
    buffer_load_dwordx4 v4, s[36:39], s3 offen lds
    s_add_u32 m0, s14, 22528
    s_add_u32 s3, s64, 331776
    s_waitcnt vmcnt(12)
    buffer_load_dwordx4 v4, s[36:39], s3 offen lds
    s_xor_b32 s23, s22, 1
    s_mov_b32 s24, 8
    s_mul_i32 s12, s7, 5
    s_cmp_eq_u32 s7, 6
    s_cselect_b32 s3, 0x7fff0000, 0
    v_mov_b32 v6, v14
    v_add_u32 v7, 1024, v14
    v_add_u32 v13, s3, v14
    s_waitcnt vmcnt(12)
    s_barrier
    s_lshl_b32 s15, s13, 7
    s_add_u32 s15, s15, s10
    s_mul_i32 s64, s13, 589824
    s_add_u32 s64, s64, s11
    s_add_u32 s13, s13, 1
    s_cmp_eq_u32 s13, 9
    s_cselect_b32 s13, 0, s13
    s_add_u32 m0, s14, 26624
    s_nop 0
    buffer_load_dwordx4 v3, s[32:35], s15 offen lds
    s_add_u32 m0, s14, 36864
    s_waitcnt vmcnt(12)
    buffer_load_dwordx4 v4, s[36:39], s64 offen lds
    s_add_u32 m0, s14, 40960
    s_add_u32 s3, s64, 36864
    s_waitcnt vmcnt(12)
    buffer_load_dwordx4 v4, s[36:39], s3 offen lds
    s_add_u32 m0, s14, 30720
    s_add_u32 s3, s15, 36864
    s_waitcnt vmcnt(12)
    buffer_load_dwordx4 v3, s[32:35], s3 offen lds
    s_add_u32 m0, s14, 45056
    s_add_u32 s3, s64, 294912
    s_waitcnt vmcnt(12)
    buffer_load_dwordx4 v4, s[36:39], s3 offen lds
    s_add_u32 m0, s14, 49152
    s_add_u32 s3, s64, 331776
    s_waitcnt vmcnt(12)
    buffer_load_dwordx4 v4, s[36:39], s3 offen lds
    v_add_u32 v8, 2048, v13
    v_add_u32 v9, 3072, v13
    v_add_u32 v13, 4096, v13
    s_and_b32 s3, s9, 1
    s_lshl_b32 s31, s3, 10
    s_mov_b32 s27, s12
    s_mul_i32 s28, s5, 622592
    s_add_u32 s28, s28, 17367040
    s_add_u32 s29, s28, 16384
    s_add_u32 s52, s44, s28
    s_addc_u32 s53, s45, 0
    s_mov_b32 s25, 0
    s_lshl_b32 s3, s3, 5
    s_add_u32 s12, s12, s3
    s_lshl_b32 s12, s12, 10
    s_mul_i32 s3, s5, 622592
    s_add_u32 s12, s12, s3
    s_add_u32 s12, s12, 16777216
    s_lshl_b32 s3, s18, 16
    s_add_u32 s94, s3, s12
    s_waitcnt vmcnt(12)
    s_barrier
    s_lshl_b32 s15, s13, 7
    s_add_u32 s15, s15, s10
    s_mul_i32 s64, s13, 589824
    s_add_u32 s64, s64, s11
    s_add_u32 s13, s13, 1
    s_cmp_eq_u32 s13, 9
    s_cselect_b32 s13, 0, s13
    s_add_u32 m0, s14, 53248
    s_nop 0
    buffer_load_dwordx4 v3, s[32:35], s15 offen lds
    s_add_u32 m0, s14, 63488
    s_waitcnt vmcnt(12)
    buffer_load_dwordx4 v4, s[36:39], s64 offen lds
    s_add_u32 m0, s14, 67584
    s_add_u32 s3, s64, 36864
    s_waitcnt vmcnt(12)
    buffer_load_dwordx4 v4, s[36:39], s3 offen lds
    s_add_u32 m0, s14, 57344
    s_add_u32 s3, s15, 36864
    s_waitcnt vmcnt(12)
    buffer_load_dwordx4 v3, s[32:35], s3 offen lds
    s_add_u32 m0, s14, 71680
    s_add_u32 s3, s64, 294912
    s_waitcnt vmcnt(12)
    buffer_load_dwordx4 v4, s[36:39], s3 offen lds
    s_add_u32 m0, s14, 75776
    s_add_u32 s3, s64, 331776
    s_waitcnt vmcnt(12)
    buffer_load_dwordx4 v4, s[36:39], s3 offen lds
    s_lshl_b32 s3, s19, 16
    s_add_u32 s95, s3, s12
    s_lshl_b32 s3, s20, 16
    s_add_u32 s96, s3, s12
    s_lshl_b32 s3, s21, 16
    s_add_u32 s97, s3, s12
    s_lshl_b32 s3, s22, 16
    s_add_u32 s98, s3, s12
    s_lshl_b32 s3, s23, 16
    s_add_u32 s99, s3, s12
    s_lshl_b32 s3, s24, 16
    s_add_u32 s100, s3, s12
    s_getreg_b32 s67, hwreg(HW_REG_XCC_ID, 0, 4)
    s_lshl_b32 s67, s67, 28
    s_mov_b32 s69, 0
    buffer_load_dwordx2 v[46:47], v40, s[56:59], s30 offen
    s_waitcnt vmcnt(13)
    s_barrier
    s_lshl_b32 s15, s13, 7
    s_add_u32 s15, s15, s10
    s_mul_i32 s64, s13, 589824
    s_add_u32 s64, s64, s11
    s_add_u32 s13, s13, 1
    s_cmp_eq_u32 s13, 9
    s_cselect_b32 s13, 0, s13
    s_add_u32 m0, s14, 79872
    s_waitcnt vmcnt(12)
    buffer_load_dwordx4 v3, s[32:35], s15 offen lds
    s_add_u32 m0, s14, 90112
    s_waitcnt vmcnt(12)
    buffer_load_dwordx4 v4, s[36:39], s64 offen lds
    s_add_u32 m0, s14, 94208
    s_add_u32 s3, s64, 36864
    s_waitcnt vmcnt(12)
    buffer_load_dwordx4 v4, s[36:39], s3 offen lds
    s_add_u32 m0, s14, 83968
    s_add_u32 s3, s15, 36864
    s_waitcnt vmcnt(12)
    buffer_load_dwordx4 v3, s[32:35], s3 offen lds
    s_add_u32 m0, s14, 98304
    s_add_u32 s3, s64, 294912
    s_waitcnt vmcnt(12)
    buffer_load_dwordx4 v4, s[36:39], s3 offen lds
    s_add_u32 m0, s14, 102400
    s_add_u32 s3, s64, 331776
    s_waitcnt vmcnt(12)
    buffer_load_dwordx4 v4, s[36:39], s3 offen lds
    s_barrier
    s_lshl_b32 s15, s13, 7
    s_add_u32 s15, s15, s10
    s_mul_i32 s64, s13, 589824
    s_add_u32 s64, s64, s11
    s_add_u32 m0, s14, 0
    s_waitcnt vmcnt(12)
    buffer_load_dwordx4 v3, s[32:35], s15 offen lds
    s_add_u32 m0, s14, 10240
    s_waitcnt vmcnt(12)
    buffer_load_dwordx4 v4, s[36:39], s64 offen lds
    s_add_u32 m0, s14, 14336
    s_add_u32 s3, s64, 36864
    s_waitcnt vmcnt(12)
    buffer_load_dwordx4 v4, s[36:39], s3 offen lds
    s_add_u32 m0, s14, 4096
    s_add_u32 s3, s15, 36864
    s_waitcnt vmcnt(12)
    buffer_load_dwordx4 v3, s[32:35], s3 offen lds
    s_add_u32 m0, s14, 18432
    s_add_u32 s3, s64, 294912
    s_waitcnt vmcnt(12)
    buffer_load_dwordx4 v4, s[36:39], s3 offen lds
    s_add_u32 m0, s14, 22528
    s_add_u32 s3, s64, 331776
    s_waitcnt vmcnt(12)
    buffer_load_dwordx4 v4, s[36:39], s3 offen lds
    s_barrier
    s_mul_i32 s64, s16, 73728
    s_add_u32 s64, s64, s65
    s_add_u32 m0, s14, 106496
    s_waitcnt vmcnt(12)
    buffer_load_dwordx4 v5, s[40:43], s64 offen lds
    s_add_u32 m0, s14, 110592
    s_add_u32 s3, s64, 18432
    s_waitcnt vmcnt(12)
    buffer_load_dwordx4 v5, s[40:43], s3 offen lds
    s_add_u32 m0, s14, 114688
    s_add_u32 s3, s64, 36864
    s_waitcnt vmcnt(12)
    buffer_load_dwordx4 v5, s[40:43], s3 offen lds
    s_add_u32 m0, s14, 118784
    s_add_u32 s3, s64, 55296
    s_waitcnt vmcnt(12)
    buffer_load_dwordx4 v5, s[40:43], s3 offen lds
    s_mul_i32 s64, s18, 73728
    s_add_u32 s64, s64, s65
    s_add_u32 m0, s14, 139264
    s_waitcnt vmcnt(12)
    buffer_load_dwordx4 v5, s[40:43], s64 offen lds
    s_add_u32 m0, s14, 143360
    s_add_u32 s3, s64, 18432
    s_waitcnt vmcnt(12)
    buffer_load_dwordx4 v5, s[40:43], s3 offen lds
    s_add_u32 m0, s14, 147456
    s_add_u32 s3, s64, 36864
    s_waitcnt vmcnt(12)
    buffer_load_dwordx4 v5, s[40:43], s3 offen lds
    s_barrier
    s_add_u32 m0, s14, 151552
    s_add_u32 s3, s64, 55296
    s_waitcnt vmcnt(12)
    buffer_load_dwordx4 v5, s[40:43], s3 offen lds
    s_mul_i32 s64, s17, 73728
    s_add_u32 s64, s64, s65
    s_add_u32 m0, s14, 122880
    s_waitcnt vmcnt(12)
    buffer_load_dwordx4 v5, s[40:43], s64 offen lds
    s_add_u32 m0, s14, 126976
    s_add_u32 s3, s64, 18432
    s_waitcnt vmcnt(12)
    buffer_load_dwordx4 v5, s[40:43], s3 offen lds
    s_add_u32 m0, s14, 131072
    s_add_u32 s3, s64, 36864
    s_waitcnt vmcnt(12)
    buffer_load_dwordx4 v5, s[40:43], s3 offen lds
    s_add_u32 m0, s14, 135168
    s_add_u32 s3, s64, 55296
    s_waitcnt vmcnt(12)
    buffer_load_dwordx4 v5, s[40:43], s3 offen lds
    s_waitcnt vmcnt(12)
    s_barrier
    s_and_b32 s3, s9, 1
    s_lshl_b32 s3, s3, 5
    s_lshl_b32 s4, s7, 6
    s_lshl_b32 s66, s8, 3
    s_add_u32 s66, s66, s4
    s_add_u32 s12, s4, s3
    s_and_b32 s10, s18, 6
    s_and_b32 s11, s20, 6
    s_and_b32 s13, s22, 6
    s_lshr_b32 s15, s27, 2
    s_min_u32 s15, s15, 6
    s_lshl_b32 s15, s15, 2
    s_add_u32 s15, s15, s3
    s_add_u32 s15, s15, 448
    s_waitcnt lgkmcnt(0)
    s_cmp_eq_u32 s68, 0
    s_cbranch_scc1 L_nr1b
L_nok1b:
    v_mov_b32 v41, s68
    s_xor_b32 s67, s67, s68
    s_mov_b64 s[68:69], 0
    s_mov_b32 s54, s67
    s_mov_b32 s55, s67
    s_mov_b64 s[32:33], 0
    s_mov_b64 s[34:35], 0
    s_mov_b64 s[36:37], 0
    s_mov_b64 s[38:39], 0
    s_mov_b64 s[56:57], 0
    s_mov_b64 s[58:59], 0
    s_mov_b64 s[60:61], 0
    s_mov_b64 s[62:63], 0
    s_mov_b64 s[26:27], 0
    s_mul_i32 s64, s19, 73728
    s_add_u32 s64, s64, s65
    s_add_u32 m0, s14, 26624
    s_waitcnt vmcnt(7)
    buffer_load_dwordx4 v5, s[40:43], s64 offen lds
    s_add_u32 m0, s14, 30720
    s_add_u32 s3, s64, 18432
    s_waitcnt vmcnt(7)
    buffer_load_dwordx4 v5, s[40:43], s3 offen lds
    s_add_u32 m0, s14, 34816
    s_add_u32 s3, s64, 36864
    s_waitcnt vmcnt(7)
    buffer_load_dwordx4 v5, s[40:43], s3 offen lds
    s_add_u32 m0, s14, 38912
    s_add_u32 s3, s64, 55296
    s_waitcnt vmcnt(7)
    buffer_load_dwordx4 v5, s[40:43], s3 offen lds
    s_mul_i32 s64, s20, 73728
    s_add_u32 s64, s64, s65
    s_add_u32 m0, s14, 53248
    s_waitcnt vmcnt(7)
    buffer_load_dwordx4 v5, s[40:43], s64 offen lds
    s_add_u32 m0, s14, 57344
    s_add_u32 s3, s64, 18432
    s_waitcnt vmcnt(7)
    buffer_load_dwordx4 v5, s[40:43], s3 offen lds
    s_add_u32 m0, s14, 61440
    s_add_u32 s3, s64, 36864
    s_waitcnt vmcnt(7)
    buffer_load_dwordx4 v5, s[40:43], s3 offen lds
    s_add_u32 m0, s14, 65536
    s_add_u32 s3, s64, 55296
    s_waitcnt vmcnt(7)
    buffer_load_dwordx4 v5, s[40:43], s3 offen lds
    s_cmp_lg_u32 s7, 6
    s_cbranch_scc1 L_nj1b
    s_mul_i32 s64, s24, 73728
    s_add_u32 s64, s64, s65
    s_add_u32 m0, s14, 47104
    s_nop 0
    buffer_load_dwordx4 v5, s[40:43], s64 offen lds
    s_add_u32 m0, s14, 47104
    s_add_u32 s3, s64, 18432
    buffer_load_dwordx4 v5, s[40:43], s3 offen lds
    s_add_u32 m0, s14, 47104
    s_add_u32 s3, s64, 36864
    buffer_load_dwordx4 v5, s[40:43], s3 offen lds
    s_add_u32 m0, s14, 47104
    s_add_u32 s3, s64, 55296
    buffer_load_dwordx4 v5, s[40:43], s3 offen lds
L_nj1b:
    s_barrier
    s_mul_i32 s64, s21, 73728
    s_add_u32 s64, s64, s65
    s_add_u32 m0, s14, 79872
    s_waitcnt vmcnt(7)
    buffer_load_dwordx4 v5, s[40:43], s64 offen lds
    s_add_u32 m0, s14, 83968
    s_add_u32 s3, s64, 18432
    s_waitcnt vmcnt(7)
    buffer_load_dwordx4 v5, s[40:43], s3 offen lds
    s_add_u32 m0, s14, 88064
    s_add_u32 s3, s64, 36864
    s_waitcnt vmcnt(7)
    buffer_load_dwordx4 v5, s[40:43], s3 offen lds
    s_add_u32 m0, s14, 92160
    s_add_u32 s3, s64, 55296
    s_waitcnt vmcnt(7)
    buffer_load_dwordx4 v5, s[40:43], s3 offen lds
    s_barrier
    s_mul_i32 s64, s22, 73728
    s_add_u32 s64, s64, s65
    s_add_u32 m0, s14, 0
    s_nop 0
    buffer_load_dwordx4 v5, s[40:43], s64 offen lds
    s_add_u32 m0, s14, 4096
    s_add_u32 s3, s64, 18432
    buffer_load_dwordx4 v5, s[40:43], s3 offen lds
    s_add_u32 m0, s14, 8192
    s_add_u32 s3, s64, 36864
    buffer_load_dwordx4 v5, s[40:43], s3 offen lds
    s_add_u32 m0, s14, 12288
    s_add_u32 s3, s64, 55296
    buffer_load_dwordx4 v5, s[40:43], s3 offen lds
    s_add_u32 m0, s14, -2048
    s_add_u32 s3, s64, -9216
    s_waitcnt vmcnt(11)
    buffer_load_dwordx4 v5, s[40:43], s3 offen lds
    s_add_u32 m0, s14, 2048
    s_add_u32 s3, s64, 9216
    s_waitcnt vmcnt(11)
    buffer_load_dwordx4 v5, s[40:43], s3 offen lds
    s_add_u32 m0, s14, 6144
    s_add_u32 s3, s64, 27648
    s_waitcnt vmcnt(11)
    buffer_load_dwordx4 v5, s[40:43], s3 offen lds
    s_add_u32 m0, s14, 10240
    s_add_u32 s3, s64, 46080
    s_waitcnt vmcnt(11)
    buffer_load_dwordx4 v5, s[40:43], s3 offen lds
    s_mul_i32 s64, s23, 73728
    s_add_u32 s64, s64, s65
    s_add_u32 m0, s14, 106496
    s_waitcnt vmcnt(11)
    buffer_load_dwordx4 v5, s[40:43], s64 offen lds
    s_add_u32 m0, s14, 110592
    s_add_u32 s3, s64, 18432
    s_waitcnt vmcnt(11)
    buffer_load_dwordx4 v5, s[40:43], s3 offen lds
    s_add_u32 m0, s14, 114688
    s_add_u32 s3, s64, 36864
    s_waitcnt vmcnt(11)
    buffer_load_dwordx4 v5, s[40:43], s3 offen lds
    s_add_u32 m0, s14, 118784
    s_add_u32 s3, s64, 55296
    s_waitcnt vmcnt(11)
    buffer_load_dwordx4 v5, s[40:43], s3 offen lds
    s_add_u32 m0, s14, 104448
    s_add_u32 s3, s64, -9216
    s_waitcnt vmcnt(11)
    buffer_load_dwordx4 v5, s[40:43], s3 offen lds
    s_add_u32 m0, s14, 108544
    s_add_u32 s3, s64, 9216
    s_waitcnt vmcnt(11)
    buffer_load_dwordx4 v5, s[40:43], s3 offen lds
    s_add_u32 m0, s14, 112640
    s_add_u32 s3, s64, 27648
    s_waitcnt vmcnt(11)
    buffer_load_dwordx4 v5, s[40:43], s3 offen lds
    s_add_u32 m0, s14, 116736
    s_add_u32 s3, s64, 46080
    s_waitcnt vmcnt(11)
    buffer_load_dwordx4 v5, s[40:43], s3 offen lds
    s_barrier
    s_mul_i32 s64, s24, 73728
    s_add_u32 s64, s64, s65
    s_add_u32 m0, s14, 122880
    s_waitcnt vmcnt(11)
    buffer_load_dwordx4 v5, s[40:43], s64 offen lds
    s_add_u32 m0, s14, 126976
    s_add_u32 s3, s64, 18432
    s_waitcnt vmcnt(11)
    buffer_load_dwordx4 v5, s[40:43], s3 offen lds
    s_add_u32 m0, s14, 131072
    s_add_u32 s3, s64, 36864
    s_waitcnt vmcnt(11)
    buffer_load_dwordx4 v5, s[40:43], s3 offen lds
    s_add_u32 m0, s14, 135168
    s_add_u32 s3, s64, 55296
    s_waitcnt vmcnt(11)
    buffer_load_dwordx4 v5, s[40:43], s3 offen lds
    s_add_u32 m0, s14, 120832
    s_add_u32 s3, s64, -9216
    s_waitcnt vmcnt(11)
    buffer_load_dwordx4 v5, s[40:43], s3 offen lds
    s_add_u32 m0, s14, 124928
    s_add_u32 s3, s64, 9216
    s_waitcnt vmcnt(11)
    buffer_load_dwordx4 v5, s[40:43], s3 offen lds
    s_add_u32 m0, s14, 129024
    s_add_u32 s3, s64, 27648
    s_waitcnt vmcnt(11)
    buffer_load_dwordx4 v5, s[40:43], s3 offen lds
    s_add_u32 m0, s14, 133120
    s_add_u32 s3, s64, 46080
    s_waitcnt vmcnt(11)
    buffer_load_dwordx4 v5, s[40:43], s3 offen lds
    s_add_u32 s68, s68, 1
    s_cmp_gt_u32 s68, 15
    s_cbranch_scc1 L_c1b_r11b
    s_load_dwordx8 s[56:63], s[52:53], s12
    s_load_dwordx2 s[26:27], s[52:53], s15
    s_add_u32 s52, s52, 1024
    s_addc_u32 s53, s53, 0
    s_waitcnt lgkmcnt(0)
L_r1b_11b:
    s_barrier
    s_mov_b32 m0, s10
    s_branch L_g1b_e12
L_q1b_e12:
    s_add_u32 s68, s68, 1
    s_cmp_gt_u32 s68, 15
    s_cbranch_scc1 L_c1b_e12
    s_load_dwordx8 s[56:63], s[52:53], s12
    s_load_dwordx2 s[26:27], s[52:53], s15
    s_add_u32 s52, s52, 1024
    s_addc_u32 s53, s53, 0
    s_waitcnt lgkmcnt(0)
L_g1b_e12:
    s_movrels_b64 vcc, s[56:57]
    s_cmp_lg_u64 vcc, s[54:55]
    s_cbranch_scc1 L_q1b_e12
    s_add_u32 m0, s31, 75776
    s_waitcnt vmcnt(11)
    buffer_load_dwordx4 v9, s[44:47], s95 offen sc1 lds
    s_mov_b32 m0, s11
    s_branch L_g1b_e14
L_q1b_e14:
    s_add_u32 s68, s68, 1
    s_cmp_gt_u32 s68, 15
    s_cbranch_scc1 L_c1b_e14
    s_load_dwordx8 s[56:63], s[52:53], s12
    s_load_dwordx2 s[26:27], s[52:53], s15
    s_add_u32 s52, s52, 1024
    s_addc_u32 s53, s53, 0
    s_waitcnt lgkmcnt(0)
L_g1b_e14:
    s_movrels_b64 vcc, s[56:57]
    s_cmp_lg_u64 vcc, s[54:55]
    s_cbranch_scc1 L_q1b_e14
    s_add_u32 m0, s31, 139264
    s_waitcnt vmcnt(11)
    buffer_load_dwordx4 v9, s[44:47], s97 offen sc1 lds
    s_mov_b32 m0, s13
    s_branch L_g1b_e16
L_q1b_e16:
    s_add_u32 s68, s68, 1
    s_cmp_gt_u32 s68, 15
    s_cbranch_scc1 L_c1b_e16
    s_load_dwordx8 s[56:63], s[52:53], s12
    s_load_dwordx2 s[26:27], s[52:53], s15
    s_add_u32 s52, s52, 1024
    s_addc_u32 s53, s53, 0
    s_waitcnt lgkmcnt(0)
L_g1b_e16:
    s_movrels_b64 vcc, s[56:57]
    s_cmp_lg_u64 vcc, s[54:55]
    s_cbranch_scc1 L_q1b_e16
    s_add_u32 m0, s31, 143360
    s_waitcnt vmcnt(11)
    buffer_load_dwordx4 v9, s[44:47], s99 offen sc1 lds
    s_waitcnt vmcnt(11)
    s_barrier
    s_add_u32 m0, s31, 149504
    s_nop 0
    buffer_load_dwordx4 v13, s[44:47], s95 offen sc1 lds
    s_add_u32 m0, s31, 153600
    s_waitcnt vmcnt(11)
    buffer_load_dwordx4 v13, s[44:47], s97 offen sc1 lds
    s_add_u32 m0, s31, 28672
    s_waitcnt vmcnt(11)
    buffer_load_dwordx4 v13, s[44:47], s99 offen sc1 lds
    s_waitcnt vmcnt(6)
    s_barrier
    s_cmp_eq_u32 s7, 6
    s_cbranch_scc1 L_lx1b
    s_waitcnt vmcnt(3)
    s_barrier
    s_branch L_seg_f1b
L_pgend2:
.fill (9472 - (L_pgend2 - standalone__dense_activation_squared_relu__sampling_kernel)) / 4, 4, 0xbf800000
L_seg_c1p:
L_comp1:
    s_memrealtime s[64:65]
    s_min_u32 s7, s7, 6
    v_lshlrev_b32 v14, 4, v2
    v_and_b32 v36, 15, v2
    v_lshrrev_b32 v37, 1, v36
    v_xor_b32 v37, v37, v33
    v_lshlrev_b32 v36, 7, v36
    v_lshl_add_u32 v6, v37, 4, v36
    v_lshrrev_b32 v36, 2, v2
    v_and_b32 v38, 3, v2
    v_lshlrev_b32 v38, 3, v38
    v_mov_b32 v54, v14
    v_and_b32 v37, 7, v36
    v_lshlrev_b32 v39, 1, v1
    v_xor_b32 v37, v37, v39
    v_lshl_add_u32 v39, v36, 8, v38
    v_lshl_add_u32 v48, v37, 5, v39
    v_xor_b32 v49, 32, v48
    v_xor_b32 v7, 64, v6
    v_add_u32 v8, 65536, v6
    v_add_u32 v50, 65536, v48
    v_add_u32 v9, 65536, v7
    v_add_u32 v51, 65536, v49
    v_add_u32 v55, 65536, v54
    v_add_u32 v10, 131072, v6
    v_add_u32 v52, 131072, v48
    v_add_u32 v11, 131072, v7
    v_add_u32 v53, 131072, v49
    v_add_u32 v56, 131072, v54
    v_lshlrev_b32 v40, 3, v33
    s_mul_i32 s4, s5, 1152
    s_lshl_b32 s3, s8, 8
    s_add_u32 s4, s4, s3
    s_lshl_b32 s3, s9, 6
    s_add_u32 s3, s3, s4
    s_waitcnt lgkmcnt(0)
    s_mov_b64 s[60:61], s[28:29]
    s_mov_b32 s62, 256
    s_mov_b32 s63, 0x20000
    s_or_b32 s4, s2, s9
    s_cmp_lg_u32 s4, 0
    s_cbranch_scc1 L_nonn
    s_mul_i32 s12, s64, 0x9E3779B1
    s_lshr_b32 s4, s12, 15
    s_xor_b32 s12, s12, s4
    s_mul_i32 s12, s12, 0x85EBCA6B
    s_lshr_b32 s4, s12, 13
    s_xor_b32 s12, s12, s4
    s_or_b32 s12, s12, 1
    s_and_b32 s12, s12, 0xFFFFFEFF
    v_mov_b32 v41, s12
    s_mov_b64 exec, 1
    buffer_store_dword v41, off, s[60:63], 0 sc1
    s_mov_b64 exec, -1
L_nonn:
    s_load_dwordx8 s[32:39], s[20:21], s3
    s_load_dwordx8 s[48:55], s[20:21], s3 offset:32
    s_mov_b64 s[44:45], s[30:31]
    s_mov_b32 s46, 268435456
    s_mov_b32 s47, 0x20000
    s_cmp_lg_u32 s9, 1
    s_cbranch_scc1 L_nt1
    s_mov_b64 s[40:41], s[22:23]
    s_mov_b32 s42, 5308416
    s_mov_b32 s43, 0x20000
    v_and_b32 v46, 1, v2
    v_mul_u32_u24 v36, 622592, v46
    v_mul_u32_u24 v37, 164096, v46
    s_mul_i32 s3, s5, 622592
    s_add_u32 s3, s3, 16777088
    v_add_u32 v36, s3, v36
    s_lshl_b32 s4, s6, 9
    s_add_u32 s3, s3, s4
    s_add_u32 s3, s3, 589696
    v_lshl_add_u32 v38, v2, 6, s3
    s_mul_i32 s3, s6, 164096
    s_add_u32 s3, s3, 23068544
    v_add_u32 v37, s3, v37
    v_cmp_gt_u32 vcc, 2, v2
    s_nop 1
    v_cndmask_b32 v36, v37, v36, vcc
    v_cmp_gt_u32 vcc, 4, v2
    s_nop 1
    v_cndmask_b32 v36, v38, v36, vcc
    s_mov_b64 exec, 0xfff
    buffer_load_dword v47, v36, s[44:47], 0 offen
    v_mul_u32_u24 v36, 662400, v46
    s_mul_i32 s3, s5, 663552
    s_mov_b64 exec, 3
    buffer_load_dword v47, v36, s[40:43], s3 offen
    s_mov_b64 exec, -1
L_nt1:
    s_lshl_b32 s3, s8, 2
    s_add_u32 s3, s3, s9
    s_lshl_b32 s3, s3, 5
    s_mul_i32 s4, s7, 5
    s_add_u32 s3, s3, s4
    s_cmp_eq_u32 s7, 6
    s_cselect_b32 s4, 0x7fff0000, 0
    v_add_u32 v12, s4, v14
    v_add_u32 v13, 4096, v12
    s_lshr_b32 s4, s9, 1
    s_xor_b32 s4, s4, s7
    s_and_b32 s4, s4, 1
    s_mul_i32 s4, s4, 26624
    s_add_u32 s4, s4, 43008
    s_and_b32 s10, s9, 1
    s_lshl_b32 s10, s10, 10
    s_add_u32 s4, s4, s10
    v_add_u32 v15, s4, v14
    s_lshl_b32 s3, s3, 10
    s_mul_i32 s11, s5, 622592
    s_add_u32 s11, s11, s3
    s_add_u32 s11, s11, 16777216
    s_lshl_b32 s4, s9, 1
    s_lshl_b32 s3, s9, 4
    s_add_u32 s3, s3, s5
    s_mul_i32 s16, s3, 2560
    s_mul_i32 s3, s6, 164096
    s_add_u32 s16, s16, s3
    s_add_u32 s16, s16, 23068672
    s_add_u32 s17, s16, 20480
    s_xor_b32 s18, s4, s5
    s_mov_b32 s19, 0x07060302
    s_mov_b32 s20, 0x10001
    v_lshrrev_b32 v37, 5, v2
    v_mul_u32_u24 v37, 19968, v37
    v_add_u32 v19, v37, v12
    v_lshlrev_b32 v17, 10, v2
    s_getreg_b32 s21, hwreg(HW_REG_XCC_ID, 0, 4)
    s_lshl_b32 s21, s21, 28
    s_lshl_b32 s3, s7, 4
    s_lshl_b32 s4, s8, 1
    s_add_u32 s3, s3, s4
    s_lshr_b32 s4, s9, 1
    s_add_u32 s3, s3, s4
    s_and_b32 s4, s9, 1
    s_lshl_b32 s4, s4, 3
    s_add_u32 s3, s3, s4
    s_lshl_b32 s3, s3, 2
    s_mul_i32 s22, s5, 622592
    s_add_u32 s22, s22, s3
    s_add_u32 s22, s22, 17367040
    s_branch L_seg_c1_0
L_seg_c1_0:
    s_waitcnt lgkmcnt(0)
    v_mov_b32 v42, s32
    v_mov_b32 v43, s33
    v_mov_b32 v44, s48
    v_mov_b32 v45, s49
    s_mov_b32 exec_lo, 0xffff0000
    v_mov_b32 v42, s34
    v_mov_b32 v43, s35
    v_mov_b32 v44, s50
    v_mov_b32 v45, s51
    s_mov_b32 exec_lo, 0
    v_mov_b32 v42, s36
    v_mov_b32 v43, s37
    v_mov_b32 v44, s52
    v_mov_b32 v45, s53
    s_mov_b32 exec_hi, 0xffff0000
    v_mov_b32 v42, s38
    v_mov_b32 v43, s39
    v_mov_b32 v44, s54
    v_mov_b32 v45, s55
    s_mov_b64 exec, -1
    s_mov_b32 s69, 0
    v_lshlrev_b32 v24, 16, v42
    v_and_b32 v25, 0xffff0000, v42
    v_lshlrev_b32 v26, 16, v43
    v_and_b32 v27, 0xffff0000, v43
    v_lshlrev_b32 v28, 16, v44
    v_and_b32 v29, 0xffff0000, v44
    v_lshlrev_b32 v30, 16, v45
    v_and_b32 v31, 0xffff0000, v45
    s_barrier
    ds_read_b64_tr_b16 v[140:141], v48 offset:10240
    ds_read_b64_tr_b16 v[142:143], v48 offset:14336
    ds_read_b64_tr_b16 v[144:145], v49 offset:10240
    ds_read_b64_tr_b16 v[146:147], v49 offset:14336
    ds_read_b128 v[60:63], v6 offset:0
    ds_read_b128 v[64:67], v6 offset:2048
    ds_read_b128 v[68:71], v6 offset:4096
    ds_read_b128 v[72:75], v6 offset:6144
    ds_read_b128 v[76:79], v6 offset:8192
    s_waitcnt lgkmcnt(4)
    v_mfma_f32_16x16x32_bf16 v[172:175], v[140:143], v[60:63], v[24:27]
    v_mfma_f32_16x16x32_bf16 v[176:179], v[144:147], v[60:63], v[28:31]
    s_waitcnt lgkmcnt(3)
    v_mfma_f32_16x16x32_bf16 v[180:183], v[140:143], v[64:67], v[24:27]
    ds_read_b64_tr_b16 v[148:149], v48 offset:18432
    ds_read_b64_tr_b16 v[150:151], v48 offset:22528
    v_mfma_f32_16x16x32_bf16 v[184:187], v[144:147], v[64:67], v[28:31]
    ds_read_b64_tr_b16 v[152:153], v49 offset:18432
    ds_read_b64_tr_b16 v[154:155], v49 offset:22528
    s_waitcnt lgkmcnt(6)
    v_mfma_f32_16x16x32_bf16 v[188:191], v[140:143], v[68:71], v[24:27]
    ds_read_b128 v[80:83], v7 offset:0
    v_mfma_f32_16x16x32_bf16 v[192:195], v[144:147], v[68:71], v[28:31]
    ds_read_b128 v[84:87], v7 offset:2048
    s_waitcnt lgkmcnt(7)
    v_mfma_f32_16x16x32_bf16 v[196:199], v[140:143], v[72:75], v[24:27]
    ds_read_b128 v[88:91], v7 offset:4096
    v_mfma_f32_16x16x32_bf16 v[200:203], v[144:147], v[72:75], v[28:31]
    ds_read_b128 v[92:95], v7 offset:6144
    s_waitcnt lgkmcnt(8)
    v_mfma_f32_16x16x32_bf16 v[204:207], v[140:143], v[76:79], v[24:27]
    ds_read_b128 v[96:99], v7 offset:8192
    v_mfma_f32_16x16x32_bf16 v[208:211], v[144:147], v[76:79], v[28:31]
    s_waitcnt lgkmcnt(0)
    s_barrier
    s_load_dword s23, s[60:61], 0
    v_mfma_f32_16x16x32_bf16 v[172:175], v[148:151], v[80:83], v[172:175]
    ds_read_b64_tr_b16 v[156:157], v48 offset:36864
    ds_read_b64_tr_b16 v[158:159], v48 offset:40960
    v_mfma_f32_16x16x32_bf16 v[176:179], v[152:155], v[80:83], v[176:179]
    ds_read_b64_tr_b16 v[160:161], v49 offset:36864
    ds_read_b64_tr_b16 v[162:163], v49 offset:40960
    v_mfma_f32_16x16x32_bf16 v[180:183], v[148:151], v[84:87], v[180:183]
    ds_read_b128 v[100:103], v6 offset:26624
    v_mfma_f32_16x16x32_bf16 v[184:187], v[152:155], v[84:87], v[184:187]
    ds_read_b128 v[104:107], v6 offset:28672
    v_mfma_f32_16x16x32_bf16 v[188:191], v[148:151], v[88:91], v[188:191]
    ds_read_b128 v[108:111], v6 offset:30720
    v_mfma_f32_16x16x32_bf16 v[192:195], v[152:155], v[88:91], v[192:195]
    ds_read_b128 v[112:115], v6 offset:32768
    v_mfma_f32_16x16x32_bf16 v[196:199], v[148:151], v[92:95], v[196:199]
    ds_read_b128 v[116:119], v6 offset:34816
    v_mfma_f32_16x16x32_bf16 v[200:203], v[152:155], v[92:95], v[200:203]
    ds_read_b64_tr_b16 v[164:165], v48 offset:45056
    ds_read_b64_tr_b16 v[166:167], v48 offset:49152
    v_mfma_f32_16x16x32_bf16 v[204:207], v[148:151], v[96:99], v[204:207]
    ds_read_b64_tr_b16 v[168:169], v49 offset:45056
    ds_read_b64_tr_b16 v[170:171], v49 offset:49152
    v_mfma_f32_16x16x32_bf16 v[208:211], v[152:155], v[96:99], v[208:211]
    ds_read_b128 v[120:123], v7 offset:26624
    s_waitcnt lgkmcnt(9)
    v_mfma_f32_16x16x32_bf16 v[172:175], v[156:159], v[100:103], v[172:175]
    ds_read_b128 v[124:127], v7 offset:28672
    v_mfma_f32_16x16x32_bf16 v[176:179], v[160:163], v[100:103], v[176:179]
    ds_read_b128 v[128:131], v7 offset:30720
    s_waitcnt lgkmcnt(10)
    v_mfma_f32_16x16x32_bf16 v[180:183], v[156:159], v[104:107], v[180:183]
    ds_read_b128 v[132:135], v7 offset:32768
    v_mfma_f32_16x16x32_bf16 v[184:187], v[160:163], v[104:107], v[184:187]
    ds_read_b128 v[136:139], v7 offset:34816
    s_waitcnt lgkmcnt(11)
    v_mfma_f32_16x16x32_bf16 v[188:191], v[156:159], v[108:111], v[188:191]
    v_mfma_f32_16x16x32_bf16 v[192:195], v[160:163], v[108:111], v[192:195]
    s_waitcnt lgkmcnt(10)
    v_mfma_f32_16x16x32_bf16 v[196:199], v[156:159], v[112:115], v[196:199]
    v_mfma_f32_16x16x32_bf16 v[200:203], v[160:163], v[112:115], v[200:203]
    s_waitcnt lgkmcnt(9)
    v_mfma_f32_16x16x32_bf16 v[204:207], v[156:159], v[116:119], v[204:207]
    v_mfma_f32_16x16x32_bf16 v[208:211], v[160:163], v[116:119], v[208:211]
    s_waitcnt lgkmcnt(0)
    s_barrier
    v_mfma_f32_16x16x32_bf16 v[172:175], v[164:167], v[120:123], v[172:175]
    ds_read_b64_tr_b16 v[140:141], v48 offset:63488
    ds_read_b64_tr_b16 v[142:143], v50 offset:2048
    v_mfma_f32_16x16x32_bf16 v[176:179], v[168:171], v[120:123], v[176:179]
    ds_read_b64_tr_b16 v[144:145], v49 offset:63488
    ds_read_b64_tr_b16 v[146:147], v51 offset:2048
    v_mfma_f32_16x16x32_bf16 v[180:183], v[164:167], v[124:127], v[180:183]
    ds_read_b128 v[60:63], v6 offset:53248
    v_mfma_f32_16x16x32_bf16 v[184:187], v[168:171], v[124:127], v[184:187]
    ds_read_b128 v[64:67], v6 offset:55296
    v_mfma_f32_16x16x32_bf16 v[188:191], v[164:167], v[128:131], v[188:191]
    ds_read_b128 v[68:71], v6 offset:57344
    v_mfma_f32_16x16x32_bf16 v[192:195], v[168:171], v[128:131], v[192:195]
    ds_read_b128 v[72:75], v6 offset:59392
    v_mfma_f32_16x16x32_bf16 v[196:199], v[164:167], v[132:135], v[196:199]
    ds_read_b128 v[76:79], v6 offset:61440
    v_mfma_f32_16x16x32_bf16 v[200:203], v[168:171], v[132:135], v[200:203]
    ds_read_b64_tr_b16 v[148:149], v50 offset:6144
    ds_read_b64_tr_b16 v[150:151], v50 offset:10240
    v_mfma_f32_16x16x32_bf16 v[204:207], v[164:167], v[136:139], v[204:207]
    ds_read_b64_tr_b16 v[152:153], v51 offset:6144
    ds_read_b64_tr_b16 v[154:155], v51 offset:10240
    v_mfma_f32_16x16x32_bf16 v[208:211], v[168:171], v[136:139], v[208:211]
    ds_read_b128 v[80:83], v7 offset:53248
    s_waitcnt lgkmcnt(9)
    v_mfma_f32_16x16x32_bf16 v[172:175], v[140:143], v[60:63], v[172:175]
    ds_read_b128 v[84:87], v7 offset:55296
    v_mfma_f32_16x16x32_bf16 v[176:179], v[144:147], v[60:63], v[176:179]
    ds_read_b128 v[88:91], v7 offset:57344
    s_waitcnt lgkmcnt(10)
    v_mfma_f32_16x16x32_bf16 v[180:183], v[140:143], v[64:67], v[180:183]
    ds_read_b128 v[92:95], v7 offset:59392
    v_mfma_f32_16x16x32_bf16 v[184:187], v[144:147], v[64:67], v[184:187]
    ds_read_b128 v[96:99], v7 offset:61440
    s_waitcnt lgkmcnt(11)
    v_mfma_f32_16x16x32_bf16 v[188:191], v[140:143], v[68:71], v[188:191]
    v_mfma_f32_16x16x32_bf16 v[192:195], v[144:147], v[68:71], v[192:195]
    s_waitcnt lgkmcnt(10)
    v_mfma_f32_16x16x32_bf16 v[196:199], v[140:143], v[72:75], v[196:199]
    v_mfma_f32_16x16x32_bf16 v[200:203], v[144:147], v[72:75], v[200:203]
    s_waitcnt lgkmcnt(9)
    v_mfma_f32_16x16x32_bf16 v[204:207], v[140:143], v[76:79], v[204:207]
    v_mfma_f32_16x16x32_bf16 v[208:211], v[144:147], v[76:79], v[208:211]
    s_waitcnt lgkmcnt(0)
    s_barrier
    v_mfma_f32_16x16x32_bf16 v[172:175], v[148:151], v[80:83], v[172:175]
    ds_read_b64_tr_b16 v[156:157], v50 offset:24576
    ds_read_b64_tr_b16 v[158:159], v50 offset:28672
    v_mfma_f32_16x16x32_bf16 v[176:179], v[152:155], v[80:83], v[176:179]
    ds_read_b64_tr_b16 v[160:161], v51 offset:24576
    ds_read_b64_tr_b16 v[162:163], v51 offset:28672
    v_mfma_f32_16x16x32_bf16 v[180:183], v[148:151], v[84:87], v[180:183]
    ds_read_b128 v[100:103], v8 offset:14336
    v_mfma_f32_16x16x32_bf16 v[184:187], v[152:155], v[84:87], v[184:187]
    ds_read_b128 v[104:107], v8 offset:16384
    v_mfma_f32_16x16x32_bf16 v[188:191], v[148:151], v[88:91], v[188:191]
    ds_read_b128 v[108:111], v8 offset:18432
    v_mfma_f32_16x16x32_bf16 v[192:195], v[152:155], v[88:91], v[192:195]
    ds_read_b128 v[112:115], v8 offset:20480
    v_mfma_f32_16x16x32_bf16 v[196:199], v[148:151], v[92:95], v[196:199]
    ds_read_b128 v[116:119], v8 offset:22528
    v_mfma_f32_16x16x32_bf16 v[200:203], v[152:155], v[92:95], v[200:203]
    ds_read_b64_tr_b16 v[164:165], v50 offset:32768
    ds_read_b64_tr_b16 v[166:167], v50 offset:36864
    v_mfma_f32_16x16x32_bf16 v[204:207], v[148:151], v[96:99], v[204:207]
    ds_read_b64_tr_b16 v[168:169], v51 offset:32768
    ds_read_b64_tr_b16 v[170:171], v51 offset:36864
    v_mfma_f32_16x16x32_bf16 v[208:211], v[152:155], v[96:99], v[208:211]
    ds_read_b128 v[120:123], v9 offset:14336
    s_waitcnt lgkmcnt(9)
    v_mfma_f32_16x16x32_bf16 v[172:175], v[156:159], v[100:103], v[172:175]
    ds_read_b128 v[124:127], v9 offset:16384
    v_mfma_f32_16x16x32_bf16 v[176:179], v[160:163], v[100:103], v[176:179]
    ds_read_b128 v[128:131], v9 offset:18432
    s_waitcnt lgkmcnt(10)
    v_mfma_f32_16x16x32_bf16 v[180:183], v[156:159], v[104:107], v[180:183]
    ds_read_b128 v[132:135], v9 offset:20480
    v_mfma_f32_16x16x32_bf16 v[184:187], v[160:163], v[104:107], v[184:187]
    ds_read_b128 v[136:139], v9 offset:22528
    s_waitcnt lgkmcnt(11)
    v_mfma_f32_16x16x32_bf16 v[188:191], v[156:159], v[108:111], v[188:191]
    v_mfma_f32_16x16x32_bf16 v[192:195], v[160:163], v[108:111], v[192:195]
    s_waitcnt lgkmcnt(10)
    v_mfma_f32_16x16x32_bf16 v[196:199], v[156:159], v[112:115], v[196:199]
    v_mfma_f32_16x16x32_bf16 v[200:203], v[160:163], v[112:115], v[200:203]
    s_waitcnt lgkmcnt(9)
    v_mfma_f32_16x16x32_bf16 v[204:207], v[156:159], v[116:119], v[204:207]
    v_mfma_f32_16x16x32_bf16 v[208:211], v[160:163], v[116:119], v[208:211]
    s_waitcnt lgkmcnt(0)
    s_barrier
    v_mfma_f32_16x16x32_bf16 v[172:175], v[164:167], v[120:123], v[172:175]
    ds_read_b64_tr_b16 v[140:141], v48 offset:10240
    ds_read_b64_tr_b16 v[142:143], v48 offset:14336
    v_mfma_f32_16x16x32_bf16 v[176:179], v[168:171], v[120:123], v[176:179]
    ds_read_b64_tr_b16 v[144:145], v49 offset:10240
    ds_read_b64_tr_b16 v[146:147], v49 offset:14336
    v_mfma_f32_16x16x32_bf16 v[180:183], v[164:167], v[124:127], v[180:183]
    ds_read_b128 v[60:63], v6 offset:0
    v_mfma_f32_16x16x32_bf16 v[184:187], v[168:171], v[124:127], v[184:187]
    ds_read_b128 v[64:67], v6 offset:2048
    v_mfma_f32_16x16x32_bf16 v[188:191], v[164:167], v[128:131], v[188:191]
    ds_read_b128 v[68:71], v6 offset:4096
    v_mfma_f32_16x16x32_bf16 v[192:195], v[168:171], v[128:131], v[192:195]
    ds_read_b128 v[72:75], v6 offset:6144
    v_mfma_f32_16x16x32_bf16 v[196:199], v[164:167], v[132:135], v[196:199]
    ds_read_b128 v[76:79], v6 offset:8192
    v_mfma_f32_16x16x32_bf16 v[200:203], v[168:171], v[132:135], v[200:203]
    ds_read_b64_tr_b16 v[148:149], v48 offset:18432
    ds_read_b64_tr_b16 v[150:151], v48 offset:22528
    v_mfma_f32_16x16x32_bf16 v[204:207], v[164:167], v[136:139], v[204:207]
    ds_read_b64_tr_b16 v[152:153], v49 offset:18432
    ds_read_b64_tr_b16 v[154:155], v49 offset:22528
    v_mfma_f32_16x16x32_bf16 v[208:211], v[168:171], v[136:139], v[208:211]
    ds_read_b128 v[80:83], v7 offset:0
    s_waitcnt lgkmcnt(9)
    v_mfma_f32_16x16x32_bf16 v[172:175], v[140:143], v[60:63], v[172:175]
    ds_read_b128 v[84:87], v7 offset:2048
    v_mfma_f32_16x16x32_bf16 v[176:179], v[144:147], v[60:63], v[176:179]
    ds_read_b128 v[88:91], v7 offset:4096
    s_waitcnt lgkmcnt(10)
    v_mfma_f32_16x16x32_bf16 v[180:183], v[140:143], v[64:67], v[180:183]
    ds_read_b128 v[92:95], v7 offset:6144
    v_mfma_f32_16x16x32_bf16 v[184:187], v[144:147], v[64:67], v[184:187]
    ds_read_b128 v[96:99], v7 offset:8192
    s_waitcnt lgkmcnt(11)
    v_mfma_f32_16x16x32_bf16 v[188:191], v[140:143], v[68:71], v[188:191]
    v_mfma_f32_16x16x32_bf16 v[192:195], v[144:147], v[68:71], v[192:195]
    s_waitcnt lgkmcnt(10)
    v_mfma_f32_16x16x32_bf16 v[196:199], v[140:143], v[72:75], v[196:199]
    v_mfma_f32_16x16x32_bf16 v[200:203], v[144:147], v[72:75], v[200:203]
    s_waitcnt lgkmcnt(9)
    v_mfma_f32_16x16x32_bf16 v[204:207], v[140:143], v[76:79], v[204:207]
    v_mfma_f32_16x16x32_bf16 v[208:211], v[144:147], v[76:79], v[208:211]
    s_waitcnt lgkmcnt(0)
    s_barrier
    v_mfma_f32_16x16x32_bf16 v[172:175], v[148:151], v[80:83], v[172:175]
    ds_read_b64_tr_b16 v[156:157], v48 offset:36864
    ds_read_b64_tr_b16 v[158:159], v48 offset:40960
    v_mfma_f32_16x16x32_bf16 v[176:179], v[152:155], v[80:83], v[176:179]
    ds_read_b64_tr_b16 v[160:161], v49 offset:36864
    ds_read_b64_tr_b16 v[162:163], v49 offset:40960
    v_mfma_f32_16x16x32_bf16 v[180:183], v[148:151], v[84:87], v[180:183]
    ds_read_b128 v[100:103], v6 offset:26624
    s_waitcnt vmcnt(0)
    s_cmp_eq_u32 s23, 0
    s_cbranch_scc1 L_nrc1
L_nokc1:
    s_xor_b32 s21, s21, s23
    v_mfma_f32_16x16x32_bf16 v[184:187], v[152:155], v[84:87], v[184:187]
    ds_read_b128 v[104:107], v6 offset:28672
    v_mov_b32 v16, s21
    v_mfma_f32_16x16x32_bf16 v[188:191], v[148:151], v[88:91], v[188:191]
    ds_read_b128 v[108:111], v6 offset:30720
    v_and_b32 v42, 3, v2
    v_mfma_f32_16x16x32_bf16 v[192:195], v[152:155], v[88:91], v[192:195]
    ds_read_b128 v[112:115], v6 offset:32768
    v_lshlrev_b32 v42, 3, v42
    v_mfma_f32_16x16x32_bf16 v[196:199], v[148:151], v[92:95], v[196:199]
    ds_read_b128 v[116:119], v6 offset:34816
    v_lshrrev_b32 v42, v42, s23
    v_mfma_f32_16x16x32_bf16 v[200:203], v[152:155], v[92:95], v[200:203]
    ds_read_b64_tr_b16 v[164:165], v48 offset:45056
    ds_read_b64_tr_b16 v[166:167], v48 offset:49152
    v_mfma_f32_16x16x32_bf16 v[204:207], v[148:151], v[96:99], v[204:207]
    ds_read_b64_tr_b16 v[168:169], v49 offset:45056
    ds_read_b64_tr_b16 v[170:171], v49 offset:49152
    v_mfma_f32_16x16x32_bf16 v[208:211], v[152:155], v[96:99], v[208:211]
    ds_read_b128 v[120:123], v7 offset:26624
    v_bfe_u32 v43, v42, 0, 1
    s_waitcnt lgkmcnt(9)
    v_mfma_f32_16x16x32_bf16 v[172:175], v[156:159], v[100:103], v[172:175]
    ds_read_b128 v[124:127], v7 offset:28672
    v_bfe_u32 v44, v42, 1, 1
    v_mfma_f32_16x16x32_bf16 v[176:179], v[160:163], v[100:103], v[176:179]
    ds_read_b128 v[128:131], v7 offset:30720
    v_lshl_or_b32 v20, v44, 16, v43
    s_waitcnt lgkmcnt(10)
    v_mfma_f32_16x16x32_bf16 v[180:183], v[156:159], v[104:107], v[180:183]
    ds_read_b128 v[132:135], v7 offset:32768
    v_bfe_u32 v43, v42, 2, 1
    v_mfma_f32_16x16x32_bf16 v[184:187], v[160:163], v[104:107], v[184:187]
    ds_read_b128 v[136:139], v7 offset:34816
    v_bfe_u32 v44, v42, 3, 1
    s_waitcnt lgkmcnt(11)
    v_mfma_f32_16x16x32_bf16 v[188:191], v[156:159], v[108:111], v[188:191]
    v_lshl_or_b32 v21, v44, 16, v43
    v_bfe_u32 v43, v42, 4, 1
    v_mfma_f32_16x16x32_bf16 v[192:195], v[160:163], v[108:111], v[192:195]
    v_bfe_u32 v44, v42, 5, 1
    v_lshl_or_b32 v22, v44, 16, v43
    s_waitcnt lgkmcnt(10)
    v_mfma_f32_16x16x32_bf16 v[196:199], v[156:159], v[112:115], v[196:199]
    v_bfe_u32 v43, v42, 6, 1
    v_bfe_u32 v44, v42, 7, 1
    v_mfma_f32_16x16x32_bf16 v[200:203], v[160:163], v[112:115], v[200:203]
    v_lshl_or_b32 v23, v44, 16, v43
    s_waitcnt lgkmcnt(9)
    v_mfma_f32_16x16x32_bf16 v[204:207], v[156:159], v[116:119], v[204:207]
    v_mfma_f32_16x16x32_bf16 v[208:211], v[160:163], v[116:119], v[208:211]
    s_waitcnt lgkmcnt(0)
    s_barrier
    v_mfma_f32_16x16x32_bf16 v[172:175], v[164:167], v[120:123], v[172:175]
    ds_read_b64_tr_b16 v[140:141], v48 offset:63488
    ds_read_b64_tr_b16 v[142:143], v50 offset:2048
    v_mfma_f32_16x16x32_bf16 v[176:179], v[168:171], v[120:123], v[176:179]
    ds_read_b64_tr_b16 v[144:145], v49 offset:63488
    ds_read_b64_tr_b16 v[146:147], v51 offset:2048
    v_mfma_f32_16x16x32_bf16 v[180:183], v[164:167], v[124:127], v[180:183]
    ds_read_b128 v[60:63], v6 offset:53248
    v_mfma_f32_16x16x32_bf16 v[184:187], v[168:171], v[124:127], v[184:187]
    ds_read_b128 v[64:67], v6 offset:55296
    v_mfma_f32_16x16x32_bf16 v[188:191], v[164:167], v[128:131], v[188:191]
    ds_read_b128 v[68:71], v6 offset:57344
    v_mfma_f32_16x16x32_bf16 v[192:195], v[168:171], v[128:131], v[192:195]
    ds_read_b128 v[72:75], v6 offset:59392
    v_mfma_f32_16x16x32_bf16 v[196:199], v[164:167], v[132:135], v[196:199]
    ds_read_b128 v[76:79], v6 offset:61440
    v_mfma_f32_16x16x32_bf16 v[200:203], v[168:171], v[132:135], v[200:203]
    ds_read_b64_tr_b16 v[148:149], v50 offset:6144
    ds_read_b64_tr_b16 v[150:151], v50 offset:10240
    v_mfma_f32_16x16x32_bf16 v[204:207], v[164:167], v[136:139], v[204:207]
    ds_read_b64_tr_b16 v[152:153], v51 offset:6144
    ds_read_b64_tr_b16 v[154:155], v51 offset:10240
    v_mfma_f32_16x16x32_bf16 v[208:211], v[168:171], v[136:139], v[208:211]
    ds_read_b128 v[80:83], v7 offset:53248
    s_waitcnt lgkmcnt(9)
    v_mfma_f32_16x16x32_bf16 v[172:175], v[140:143], v[60:63], v[172:175]
    ds_read_b128 v[84:87], v7 offset:55296
    v_mfma_f32_16x16x32_bf16 v[176:179], v[144:147], v[60:63], v[176:179]
    ds_read_b128 v[88:91], v7 offset:57344
    s_waitcnt lgkmcnt(10)
    v_mfma_f32_16x16x32_bf16 v[180:183], v[140:143], v[64:67], v[180:183]
    ds_read_b128 v[92:95], v7 offset:59392
    v_mfma_f32_16x16x32_bf16 v[184:187], v[144:147], v[64:67], v[184:187]
    ds_read_b128 v[96:99], v7 offset:61440
    s_waitcnt lgkmcnt(11)
    v_mfma_f32_16x16x32_bf16 v[188:191], v[140:143], v[68:71], v[188:191]
    v_mfma_f32_16x16x32_bf16 v[192:195], v[144:147], v[68:71], v[192:195]
    s_waitcnt lgkmcnt(10)
    v_mfma_f32_16x16x32_bf16 v[196:199], v[140:143], v[72:75], v[196:199]
    v_mfma_f32_16x16x32_bf16 v[200:203], v[144:147], v[72:75], v[200:203]
    s_waitcnt lgkmcnt(9)
    v_mfma_f32_16x16x32_bf16 v[204:207], v[140:143], v[76:79], v[204:207]
    v_mfma_f32_16x16x32_bf16 v[208:211], v[144:147], v[76:79], v[208:211]
    s_waitcnt lgkmcnt(0)
    s_barrier
    v_mfma_f32_16x16x32_bf16 v[172:175], v[148:151], v[80:83], v[172:175]
    ds_read_b64_tr_b16 v[156:157], v50 offset:24576
    ds_read_b64_tr_b16 v[158:159], v50 offset:28672
    v_mfma_f32_16x16x32_bf16 v[176:179], v[152:155], v[80:83], v[176:179]
    ds_read_b64_tr_b16 v[160:161], v51 offset:24576
    ds_read_b64_tr_b16 v[162:163], v51 offset:28672
    v_mfma_f32_16x16x32_bf16 v[180:183], v[148:151], v[84:87], v[180:183]
    ds_read_b128 v[100:103], v8 offset:14336
    v_mfma_f32_16x16x32_bf16 v[184:187], v[152:155], v[84:87], v[184:187]
    ds_read_b128 v[104:107], v8 offset:16384
    v_mfma_f32_16x16x32_bf16 v[188:191], v[148:151], v[88:91], v[188:191]
    ds_read_b128 v[108:111], v8 offset:18432
    v_mfma_f32_16x16x32_bf16 v[192:195], v[152:155], v[88:91], v[192:195]
    ds_read_b128 v[112:115], v8 offset:20480
    v_mfma_f32_16x16x32_bf16 v[196:199], v[148:151], v[92:95], v[196:199]
    ds_read_b128 v[116:119], v8 offset:22528
    v_mfma_f32_16x16x32_bf16 v[200:203], v[152:155], v[92:95], v[200:203]
    ds_read_b64_tr_b16 v[164:165], v50 offset:32768
    ds_read_b64_tr_b16 v[166:167], v50 offset:36864
    v_mfma_f32_16x16x32_bf16 v[204:207], v[148:151], v[96:99], v[204:207]
    ds_read_b64_tr_b16 v[168:169], v51 offset:32768
    ds_read_b64_tr_b16 v[170:171], v51 offset:36864
    v_mfma_f32_16x16x32_bf16 v[208:211], v[152:155], v[96:99], v[208:211]
    ds_read_b128 v[120:123], v9 offset:14336
    s_waitcnt lgkmcnt(9)
    v_mfma_f32_16x16x32_bf16 v[172:175], v[156:159], v[100:103], v[172:175]
    ds_read_b128 v[124:127], v9 offset:16384
    v_mfma_f32_16x16x32_bf16 v[176:179], v[160:163], v[100:103], v[176:179]
    ds_read_b128 v[128:131], v9 offset:18432
    s_waitcnt lgkmcnt(10)
    v_mfma_f32_16x16x32_bf16 v[180:183], v[156:159], v[104:107], v[180:183]
    ds_read_b128 v[132:135], v9 offset:20480
    v_mfma_f32_16x16x32_bf16 v[184:187], v[160:163], v[104:107], v[184:187]
    ds_read_b128 v[136:139], v9 offset:22528
    s_waitcnt lgkmcnt(11)
    v_mfma_f32_16x16x32_bf16 v[188:191], v[156:159], v[108:111], v[188:191]
    v_mfma_f32_16x16x32_bf16 v[192:195], v[160:163], v[108:111], v[192:195]
    s_waitcnt lgkmcnt(10)
    v_mfma_f32_16x16x32_bf16 v[196:199], v[156:159], v[112:115], v[196:199]
    v_mfma_f32_16x16x32_bf16 v[200:203], v[160:163], v[112:115], v[200:203]
    s_waitcnt lgkmcnt(9)
    v_mfma_f32_16x16x32_bf16 v[204:207], v[156:159], v[116:119], v[204:207]
    v_mfma_f32_16x16x32_bf16 v[208:211], v[160:163], v[116:119], v[208:211]
    s_waitcnt lgkmcnt(0)
    s_branch L_seg_c1_8
L_pgend3:
.fill (13568 - (L_pgend3 - standalone__dense_activation_squared_relu__sampling_kernel)) / 4, 4, 0xbf800000
L_seg_c1_8:
    s_barrier
    v_mfma_f32_16x16x32_bf16 v[172:175], v[164:167], v[120:123], v[172:175]
    ds_read_b64_tr_b16 v[140:141], v48 offset:10240
    ds_read_b64_tr_b16 v[142:143], v48 offset:14336
    v_mfma_f32_16x16x32_bf16 v[176:179], v[168:171], v[120:123], v[176:179]
    ds_read_b64_tr_b16 v[144:145], v49 offset:10240
    ds_read_b64_tr_b16 v[146:147], v49 offset:14336
    v_mfma_f32_16x16x32_bf16 v[180:183], v[164:167], v[124:127], v[180:183]
    ds_read_b128 v[60:63], v6 offset:0
    v_mfma_f32_16x16x32_bf16 v[184:187], v[168:171], v[124:127], v[184:187]
    ds_read_b64_tr_b16 v[148:149], v48 offset:18432
    ds_read_b64_tr_b16 v[150:151], v48 offset:22528
    v_mfma_f32_16x16x32_bf16 v[188:191], v[164:167], v[128:131], v[188:191]
    ds_read_b64_tr_b16 v[152:153], v49 offset:18432
    ds_read_b64_tr_b16 v[154:155], v49 offset:22528
    v_mfma_f32_16x16x32_bf16 v[192:195], v[168:171], v[128:131], v[192:195]
    ds_read_b128 v[80:83], v7 offset:0
    v_mfma_f32_16x16x32_bf16 v[196:199], v[164:167], v[132:135], v[196:199]
    ds_read_b128 v[64:67], v6 offset:2048
    v_mfma_f32_16x16x32_bf16 v[200:203], v[168:171], v[132:135], v[200:203]
    ds_read_b128 v[84:87], v7 offset:2048
    v_mfma_f32_16x16x32_bf16 v[204:207], v[164:167], v[136:139], v[204:207]
    ds_read_b128 v[68:71], v6 offset:4096
    v_mfma_f32_16x16x32_bf16 v[208:211], v[168:171], v[136:139], v[208:211]
    ds_read_b128 v[88:91], v7 offset:4096
    s_waitcnt lgkmcnt(9)
    v_mfma_f32_16x16x32_bf16 v[172:175], v[140:143], v[60:63], v[172:175]
    ds_read_b128 v[72:75], v6 offset:6144
    v_mfma_f32_16x16x32_bf16 v[176:179], v[144:147], v[60:63], v[176:179]
    ds_read_b128 v[92:95], v7 offset:6144
    s_waitcnt lgkmcnt(6)
    v_mfma_f32_16x16x32_bf16 v[172:175], v[148:151], v[80:83], v[172:175]
    ds_read_b128 v[76:79], v6 offset:8192
    v_mfma_f32_16x16x32_bf16 v[176:179], v[152:155], v[80:83], v[176:179]
    ds_read_b128 v[96:99], v7 offset:8192
    s_waitcnt lgkmcnt(7)
    v_mfma_f32_16x16x32_bf16 v[180:183], v[140:143], v[64:67], v[180:183]
    v_mfma_f32_16x16x32_bf16 v[184:187], v[144:147], v[64:67], v[184:187]
    s_waitcnt lgkmcnt(6)
    v_mfma_f32_16x16x32_bf16 v[180:183], v[148:151], v[84:87], v[180:183]
    v_max_f32 v32, 0, v172
    v_max_f32 v33, 0, v173
    v_mfma_f32_16x16x32_bf16 v[184:187], v[152:155], v[84:87], v[184:187]
    v_max_f32 v34, 0, v174
    v_max_f32 v35, 0, v175
    s_waitcnt lgkmcnt(5)
    v_mfma_f32_16x16x32_bf16 v[188:191], v[140:143], v[68:71], v[188:191]
    v_pk_mul_f32 v[32:33], v[32:33], v[32:33]
    v_pk_mul_f32 v[34:35], v[34:35], v[34:35]
    v_mfma_f32_16x16x32_bf16 v[192:195], v[144:147], v[68:71], v[192:195]
    v_max_f32 v36, 0, v176
    v_max_f32 v37, 0, v177
    s_waitcnt lgkmcnt(4)
    v_mfma_f32_16x16x32_bf16 v[188:191], v[148:151], v[88:91], v[188:191]
    v_max_f32 v38, 0, v178
    v_max_f32 v39, 0, v179
    v_mfma_f32_16x16x32_bf16 v[192:195], v[152:155], v[88:91], v[192:195]
    v_pk_mul_f32 v[36:37], v[36:37], v[36:37]
    v_pk_mul_f32 v[38:39], v[38:39], v[38:39]
    s_waitcnt lgkmcnt(3)
    v_mfma_f32_16x16x32_bf16 v[196:199], v[140:143], v[72:75], v[196:199]
    v_cvt_pk_bf16_f32 v232, v32, v33
    v_cvt_pk_bf16_f32 v233, v34, v35
    v_mfma_f32_16x16x32_bf16 v[200:203], v[144:147], v[72:75], v[200:203]
    v_cvt_pk_bf16_f32 v234, v36, v37
    v_cvt_pk_bf16_f32 v235, v38, v39
    s_waitcnt lgkmcnt(2)
    v_mfma_f32_16x16x32_bf16 v[196:199], v[148:151], v[92:95], v[196:199]
    buffer_store_dwordx4 v[232:235], v14, s[44:47], s11 offen offset:0 sc1
    v_max_f32 v40, 0, v180
    v_mfma_f32_16x16x32_bf16 v[200:203], v[152:155], v[92:95], v[200:203]
    v_max_f32 v41, 0, v181
    v_max_f32 v42, 0, v182
    s_waitcnt lgkmcnt(1)
    v_mfma_f32_16x16x32_bf16 v[204:207], v[140:143], v[76:79], v[204:207]
    v_max_f32 v43, 0, v183
    v_pk_mul_f32 v[40:41], v[40:41], v[40:41]
    v_mfma_f32_16x16x32_bf16 v[208:211], v[144:147], v[76:79], v[208:211]
    v_pk_mul_f32 v[42:43], v[42:43], v[42:43]
    v_max_f32 v44, 0, v184
    s_waitcnt lgkmcnt(0)
    v_mfma_f32_16x16x32_bf16 v[204:207], v[148:151], v[96:99], v[204:207]
    v_max_f32 v45, 0, v185
    v_max_f32 v46, 0, v186
    v_mfma_f32_16x16x32_bf16 v[208:211], v[152:155], v[96:99], v[208:211]
    v_max_f32 v47, 0, v187
    v_pk_mul_f32 v[44:45], v[44:45], v[44:45]
    v_pk_mul_f32 v[46:47], v[46:47], v[46:47]
    v_cvt_pk_bf16_f32 v236, v40, v41
    v_cvt_pk_bf16_f32 v237, v42, v43
    v_cvt_pk_bf16_f32 v238, v44, v45
    v_cvt_pk_bf16_f32 v239, v46, v47
    buffer_store_dwordx4 v[236:239], v14, s[44:47], s11 offen offset:1024 sc1
    v_max_f32 v32, 0, v188
    v_max_f32 v33, 0, v189
    v_max_f32 v34, 0, v190
    v_max_f32 v35, 0, v191
    v_pk_mul_f32 v[32:33], v[32:33], v[32:33]
    v_pk_mul_f32 v[34:35], v[34:35], v[34:35]
    v_max_f32 v36, 0, v192
    v_max_f32 v37, 0, v193
    v_max_f32 v38, 0, v194
    v_max_f32 v39, 0, v195
    v_pk_mul_f32 v[36:37], v[36:37], v[36:37]
    v_pk_mul_f32 v[38:39], v[38:39], v[38:39]
    v_cvt_pk_bf16_f32 v240, v32, v33
    v_cvt_pk_bf16_f32 v241, v34, v35
    v_cvt_pk_bf16_f32 v242, v36, v37
    v_cvt_pk_bf16_f32 v243, v38, v39
    buffer_store_dwordx4 v[240:243], v12, s[44:47], s11 offen offset:2048 sc1
    v_max_f32 v40, 0, v196
    v_max_f32 v41, 0, v197
    v_max_f32 v42, 0, v198
    v_max_f32 v43, 0, v199
    v_pk_mul_f32 v[40:41], v[40:41], v[40:41]
    v_pk_mul_f32 v[42:43], v[42:43], v[42:43]
    v_max_f32 v44, 0, v200
    v_max_f32 v45, 0, v201
    v_max_f32 v46, 0, v202
    v_max_f32 v47, 0, v203
    v_pk_mul_f32 v[44:45], v[44:45], v[44:45]
    v_pk_mul_f32 v[46:47], v[46:47], v[46:47]
    v_cvt_pk_bf16_f32 v244, v40, v41
    v_cvt_pk_bf16_f32 v245, v42, v43
    v_cvt_pk_bf16_f32 v246, v44, v45
    v_cvt_pk_bf16_f32 v247, v46, v47
    buffer_store_dwordx4 v[244:247], v12, s[44:47], s11 offen offset:3072 sc1
    v_max_f32 v32, 0, v204
    v_max_f32 v33, 0, v205
    v_max_f32 v34, 0, v206
    v_max_f32 v35, 0, v207
    v_pk_mul_f32 v[32:33], v[32:33], v[32:33]
    v_pk_mul_f32 v[34:35], v[34:35], v[34:35]
    v_max_f32 v36, 0, v208
    v_max_f32 v37, 0, v209
    v_max_f32 v38, 0, v210
    v_max_f32 v39, 0, v211
    v_pk_mul_f32 v[36:37], v[36:37], v[36:37]
    v_pk_mul_f32 v[38:39], v[38:39], v[38:39]
    v_cvt_pk_bf16_f32 v248, v32, v33
    v_cvt_pk_bf16_f32 v249, v34, v35
    v_cvt_pk_bf16_f32 v250, v36, v37
    v_cvt_pk_bf16_f32 v251, v38, v39
    buffer_store_dwordx4 v[248:251], v13, s[44:47], s11 offen sc1
    ds_write_b128 v15, v[232:235] offset:0
    ds_write_b128 v15, v[236:239] offset:2048
    ds_write_b128 v15, v[240:243] offset:4096
    ds_write_b128 v15, v[244:247] offset:6144
    ds_write_b128 v15, v[248:251] offset:8192
    s_waitcnt vmcnt(3)
    s_mov_b64 exec, 32767
    buffer_store_dword v16, v17, s[44:47], s22 offen offset:512
    s_mov_b64 exec, -1
    s_barrier
    ds_read_b64_tr_b16 v[100:101], v50 offset:40960
    ds_read_b64_tr_b16 v[102:103], v50 offset:45056
    ds_read_b64_tr_b16 v[104:105], v51 offset:40960
    ds_read_b64_tr_b16 v[106:107], v51 offset:45056
    ds_read_b64_tr_b16 v[108:109], v50 offset:49152
    ds_read_b64_tr_b16 v[110:111], v50 offset:53248
    ds_read_b64_tr_b16 v[112:113], v51 offset:49152
    ds_read_b64_tr_b16 v[114:115], v51 offset:53248
    ds_read_b64_tr_b16 v[116:117], v50 offset:57344
    ds_read_b64_tr_b16 v[118:119], v50 offset:61440
    s_waitcnt lgkmcnt(9)
    ds_read_b64_tr_b16 v[120:121], v51 offset:57344
    ds_read_b64_tr_b16 v[122:123], v51 offset:61440
    ds_read_b64_tr_b16 v[124:125], v52 offset:0
    ds_read_b64_tr_b16 v[126:127], v52 offset:4096
    ds_read_b64_tr_b16 v[128:129], v53 offset:0
    ds_read_b64_tr_b16 v[130:131], v53 offset:4096
    s_waitcnt lgkmcnt(0)
    s_barrier
    ds_read_b128 v[60:63], v54 offset:43008
    ds_read_b128 v[64:67], v54 offset:45056
    ds_read_b128 v[68:71], v54 offset:47104
    ds_read_b128 v[72:75], v54 offset:49152
    ds_read_b128 v[76:79], v54 offset:51200
    ds_read_b128 v[80:83], v54 offset:44032
    s_waitcnt lgkmcnt(5)
    v_mfma_f32_16x16x32_bf16 v[212:215], v[100:103], v[60:63], 0
    ds_read_b128 v[84:87], v54 offset:46080
    v_mfma_f32_16x16x32_bf16 v[216:219], v[104:107], v[60:63], 0
    ds_read_b128 v[88:91], v54 offset:48128
    s_waitcnt lgkmcnt(6)
    v_mfma_f32_16x16x32_bf16 v[220:223], v[100:103], v[64:67], 0
    s_waitcnt vmcnt(1)
    s_mov_b64 exec, 32767
    buffer_store_dword v16, v17, s[44:47], s22 offen offset:0
    s_mov_b64 exec, -1
    ds_read_b128 v[92:95], v54 offset:50176
    v_mfma_f32_16x16x32_bf16 v[224:227], v[104:107], v[64:67], 0
    ds_read_b128 v[96:99], v54 offset:52224
    s_waitcnt lgkmcnt(7)
    v_mfma_f32_16x16x32_bf16 v[228:231], v[100:103], v[68:71], 0
    ds_read_b128 v[132:135], v55 offset:4096
    v_mfma_f32_16x16x32_bf16 v[232:235], v[104:107], v[68:71], 0
    ds_read_b128 v[136:139], v55 offset:6144
    s_waitcnt lgkmcnt(8)
    v_mfma_f32_16x16x32_bf16 v[236:239], v[100:103], v[72:75], 0
    ds_read_b128 v[140:143], v55 offset:8192
    v_mfma_f32_16x16x32_bf16 v[240:243], v[104:107], v[72:75], 0
    ds_read_b128 v[144:147], v55 offset:10240
    s_waitcnt lgkmcnt(8)
    v_mfma_f32_16x16x32_bf16 v[244:247], v[100:103], v[76:79], 0
    ds_read_b128 v[148:151], v55 offset:12288
    v_mfma_f32_16x16x32_bf16 v[248:251], v[104:107], v[76:79], 0
    ds_read_b128 v[152:155], v55 offset:5120
    v_mfma_f32_16x16x32_bf16 v[212:215], v[108:111], v[80:83], v[212:215]
    ds_read_b128 v[156:159], v55 offset:7168
    v_mfma_f32_16x16x32_bf16 v[216:219], v[112:115], v[80:83], v[216:219]
    ds_read_b128 v[160:163], v55 offset:9216
    s_waitcnt lgkmcnt(8)
    v_mfma_f32_16x16x32_bf16 v[220:223], v[108:111], v[84:87], v[220:223]
    ds_read_b128 v[164:167], v55 offset:11264
    v_mfma_f32_16x16x32_bf16 v[224:227], v[112:115], v[84:87], v[224:227]
    ds_read_b128 v[168:171], v55 offset:13312
    v_mfma_f32_16x16x32_bf16 v[228:231], v[108:111], v[88:91], v[228:231]
    ds_read_b64_tr_b16 v[172:173], v52 offset:8192
    ds_read_b64_tr_b16 v[174:175], v52 offset:12288
    v_mfma_f32_16x16x32_bf16 v[232:235], v[112:115], v[88:91], v[232:235]
    ds_read_b64_tr_b16 v[176:177], v53 offset:8192
    s_waitcnt lgkmcnt(9)
    v_mfma_f32_16x16x32_bf16 v[236:239], v[108:111], v[92:95], v[236:239]
    ds_read_b64_tr_b16 v[178:179], v53 offset:12288
    ds_read_b64_tr_b16 v[180:181], v52 offset:16384
    v_mfma_f32_16x16x32_bf16 v[240:243], v[112:115], v[92:95], v[240:243]
    ds_read_b64_tr_b16 v[182:183], v52 offset:20480
    ds_read_b64_tr_b16 v[184:185], v53 offset:16384
    v_mfma_f32_16x16x32_bf16 v[244:247], v[108:111], v[96:99], v[244:247]
    v_mfma_f32_16x16x32_bf16 v[248:251], v[112:115], v[96:99], v[248:251]
    s_waitcnt lgkmcnt(9)
    ds_read_b64_tr_b16 v[186:187], v53 offset:20480
    v_mfma_f32_16x16x32_bf16 v[212:215], v[116:119], v[132:135], v[212:215]
    ds_read_b64_tr_b16 v[188:189], v48 offset:26624
    ds_read_b64_tr_b16 v[190:191], v48 offset:30720
    v_mfma_f32_16x16x32_bf16 v[216:219], v[120:123], v[132:135], v[216:219]
    ds_read_b64_tr_b16 v[192:193], v49 offset:26624
    v_mfma_f32_16x16x32_bf16 v[220:223], v[116:119], v[136:139], v[220:223]
    s_waitcnt lgkmcnt(9)
    ds_read_b64_tr_b16 v[194:195], v49 offset:30720
    v_mfma_f32_16x16x32_bf16 v[224:227], v[120:123], v[136:139], v[224:227]
    ds_read_b64_tr_b16 v[196:197], v48 offset:34816
    ds_read_b64_tr_b16 v[198:199], v48 offset:38912
    v_mfma_f32_16x16x32_bf16 v[228:231], v[116:119], v[140:143], v[228:231]
    ds_read_b64_tr_b16 v[200:201], v49 offset:34816
    v_mfma_f32_16x16x32_bf16 v[232:235], v[120:123], v[140:143], v[232:235]
    s_waitcnt lgkmcnt(8)
    ds_read_b64_tr_b16 v[202:203], v49 offset:38912
    v_mfma_f32_16x16x32_bf16 v[236:239], v[116:119], v[144:147], v[236:239]
    v_mfma_f32_16x16x32_bf16 v[240:243], v[120:123], v[144:147], v[240:243]
    v_mfma_f32_16x16x32_bf16 v[244:247], v[116:119], v[148:151], v[244:247]
    v_mfma_f32_16x16x32_bf16 v[248:251], v[120:123], v[148:151], v[248:251]
    s_branch L_seg_c1_10
L_seg_tl:
L_fin:
L_end:
    s_endpgm
L_vp1a:
    v_and_b32 v11, 7, v2
    v_lshlrev_b32 v11, 2, v11
    v_add_u32 v12, s12, v11
    v_and_b32 v11, 4, v11
    v_add_u32 v11, s15, v11
    v_cmp_gt_u32 vcc, 8, v2
    s_nop 1
    v_cndmask_b32 v12, v11, v12, vcc
    v_and_b32 v11, 1, v2
    v_lshlrev_b32 v11, 5, v11
    v_and_b32 v10, 2, v2
    v_lshl_add_u32 v11, v10, 1, v11
    v_add_u32 v11, s66, v11
    v_cmp_gt_u32 vcc, 16, v2
    s_nop 1
    v_cndmask_b32 v12, v11, v12, vcc
    v_mov_b32 v10, 0
    s_mov_b32 s4, -1
L_vl1a:
    s_add_u32 s69, s69, 1
    s_cmp_gt_u32 s69, 262144
    s_cbranch_scc1 L_vd1a
    s_and_b32 s3, s69, 15
    s_cbranch_scc1 L_hl1a
    s_and_b32 s3, s4, 0xf0000
    s_cbranch_scc1 L_hl1a
    buffer_wbl2 sc1
    s_waitcnt vmcnt(0)
    s_mov_b64 exec, 0xf0000
    buffer_store_dword v41, v12, s[44:47], s29 offen sc1
    s_mov_b64 exec, -1
    s_mov_b32 s25, 1
L_hl1a:
    buffer_load_dword v11, v12, s[44:47], s28 offen sc1
    s_cmp_eq_u32 s25, 0
    s_cbranch_scc1 L_hf1a
    buffer_load_dword v10, v12, s[44:47], s29 offen sc1
L_hf1a:
    s_waitcnt vmcnt(0)
    v_cmp_ne_u32 vcc, s67, v11
    v_cmp_ne_u32 s[32:33], v41, v10
    s_nop 2
    s_or_b32 s32, s32, 0xf0000
    s_and_b32 s32, vcc_lo, s32
    s_and_b32 s4, s4, s32
    s_and_b32 s3, s4, 0xffff
    s_cbranch_scc1 L_vl1a
L_vd1a:
    s_mov_b64 s[32:33], s[54:55]
    s_mov_b64 s[34:35], s[54:55]
    s_mov_b64 s[36:37], s[54:55]
    s_mov_b64 s[38:39], s[54:55]
    s_mov_b64 s[56:57], s[54:55]
    s_mov_b64 s[58:59], s[54:55]
    s_mov_b64 s[60:61], s[54:55]
    s_mov_b64 s[62:63], s[54:55]
    s_mov_b64 s[26:27], s[54:55]
    s_setpc_b64 s[0:1]
L_nr1a:
    s_add_u32 s69, s69, 1
    s_cmp_gt_u32 s69, 262144
    s_cbranch_scc1 L_nok1a
    buffer_load_dword v41, off, s[60:63], 0 sc1
    s_waitcnt vmcnt(0)
    v_readfirstlane_b32 s68, v41
    s_cmp_eq_u32 s68, 0
    s_cbranch_scc1 L_nr1a
    s_branch L_nok1a
L_c1a_a11:
    s_call_b64 s[0:1], L_vp1a
    s_branch L_g1a_a11
L_c1a_a13:
    s_call_b64 s[0:1], L_vp1a
    s_branch L_g1a_a13
L_c1a_a15:
    s_call_b64 s[0:1], L_vp1a
    s_branch L_g1a_a15
L_c1a_r10b:
    s_call_b64 s[0:1], L_vp1a
    s_branch L_r1a_10b
L_c1a_a17:
    s_call_b64 s[0:1], L_vp1a
    s_branch L_g1a_a17
L_c1a_d11:
    s_call_b64 s[0:1], L_vp1a
    s_branch L_g1a_d11
L_c1a_d13:
    s_call_b64 s[0:1], L_vp1a
    s_branch L_g1a_d13
L_c1a_d15:
    s_call_b64 s[0:1], L_vp1a
    s_branch L_g1a_d15
L_vp1b:
    v_and_b32 v11, 7, v2
    v_lshlrev_b32 v11, 2, v11
    v_add_u32 v12, s12, v11
    v_and_b32 v11, 4, v11
    v_add_u32 v11, s15, v11
    v_cmp_gt_u32 vcc, 8, v2
    s_nop 1
    v_cndmask_b32 v12, v11, v12, vcc
    v_and_b32 v11, 1, v2
    v_lshlrev_b32 v11, 5, v11
    v_and_b32 v10, 2, v2
    v_lshl_add_u32 v11, v10, 1, v11
    v_add_u32 v11, s66, v11
    v_cmp_gt_u32 vcc, 16, v2
    s_nop 1
    v_cndmask_b32 v12, v11, v12, vcc
    v_mov_b32 v10, 0
    s_mov_b32 s4, -1
L_vl1b:
    s_add_u32 s69, s69, 1
    s_cmp_gt_u32 s69, 262144
    s_cbranch_scc1 L_vd1b
    s_and_b32 s3, s69, 15
    s_cbranch_scc1 L_hl1b
    s_and_b32 s3, s4, 0xf0000
    s_cbranch_scc1 L_hl1b
    buffer_wbl2 sc1
    s_waitcnt vmcnt(0)
    s_mov_b64 exec, 0xf0000
    buffer_store_dword v41, v12, s[44:47], s29 offen sc1
    s_mov_b64 exec, -1
    s_mov_b32 s25, 1
L_hl1b:
    buffer_load_dword v11, v12, s[44:47], s28 offen sc1
    s_cmp_eq_u32 s25, 0
    s_cbranch_scc1 L_hf1b
    buffer_load_dword v10, v12, s[44:47], s29 offen sc1
L_hf1b:
    s_waitcnt vmcnt(0)
    v_cmp_ne_u32 vcc, s67, v11
    v_cmp_ne_u32 s[32:33], v41, v10
    s_nop 2
    s_or_b32 s32, s32, 0xf0000
    s_and_b32 s32, vcc_lo, s32
    s_and_b32 s4, s4, s32
    s_and_b32 s3, s4, 0xffff
    s_cbranch_scc1 L_vl1b
L_vd1b:
    s_mov_b64 s[32:33], s[54:55]
    s_mov_b64 s[34:35], s[54:55]
    s_mov_b64 s[36:37], s[54:55]
    s_mov_b64 s[38:39], s[54:55]
    s_mov_b64 s[56:57], s[54:55]
    s_mov_b64 s[58:59], s[54:55]
    s_mov_b64 s[60:61], s[54:55]
    s_mov_b64 s[62:63], s[54:55]
    s_mov_b64 s[26:27], s[54:55]
    s_setpc_b64 s[0:1]
L_nr1b:
    s_add_u32 s69, s69, 1
    s_cmp_gt_u32 s69, 262144
    s_cbranch_scc1 L_nok1b
    buffer_load_dword v41, off, s[60:63], 0 sc1
    s_waitcnt vmcnt(0)
    v_readfirstlane_b32 s68, v41
    s_cmp_eq_u32 s68, 0
    s_cbranch_scc1 L_nr1b
    s_branch L_nok1b
L_c1b_r11b:
    s_call_b64 s[0:1], L_vp1b
    s_branch L_r1b_11b
L_c1b_e12:
    s_call_b64 s[0:1], L_vp1b
    s_branch L_g1b_e12
L_c1b_e14:
    s_call_b64 s[0:1], L_vp1b
    s_branch L_g1b_e14
L_c1b_e16:
    s_call_b64 s[0:1], L_vp1b
    s_branch L_g1b_e16
L_vp2a:
    v_and_b32 v11, 7, v2
    v_lshlrev_b32 v11, 2, v11
    s_and_b32 s3, s10, 0x1ff
    s_and_b32 s4, s11, 0x1ff
    v_add_u32 v12, s3, v11
    v_add_u32 v11, s4, v11
    v_cmp_gt_u32 vcc, 8, v2
    s_nop 1
    v_cndmask_b32 v12, v11, v12, vcc
    v_and_b32 v11, 1, v2
    v_lshlrev_b32 v11, 5, v11
    v_and_b32 v10, 2, v2
    v_lshl_add_u32 v11, v10, 1, v11
    v_add_u32 v11, s66, v11
    v_cmp_gt_u32 vcc, 16, v2
    s_nop 1
    v_cndmask_b32 v12, v11, v12, vcc
    v_mov_b32 v10, 0
    s_mov_b32 s4, -1
L_vl2a:
    s_add_u32 s69, s69, 1
    s_cmp_gt_u32 s69, 262144
    s_cbranch_scc1 L_vd2a
    s_and_b32 s3, s69, 15
    s_cbranch_scc1 L_hl2a
    s_and_b32 s3, s4, 0xf0000
    s_cbranch_scc1 L_hl2a
    buffer_wbl2 sc1
    s_waitcnt vmcnt(0)
    s_mov_b64 exec, 0xf0000
    buffer_store_dword v41, v12, s[44:47], s29 offen sc1
    s_mov_b64 exec, -1
    s_mov_b32 s25, 1
L_hl2a:
    buffer_load_dword v11, v12, s[44:47], s28 offen sc1
    s_cmp_eq_u32 s25, 0
    s_cbranch_scc1 L_hf2a
    buffer_load_dword v10, v12, s[44:47], s29 offen sc1
L_hf2a:
    s_waitcnt vmcnt(0)
    v_cmp_ne_u32 vcc, s67, v11
    v_cmp_ne_u32 s[32:33], v41, v10
    s_nop 2
    s_or_b32 s32, s32, 0xf0000
    s_and_b32 s32, vcc_lo, s32
    s_and_b32 s4, s4, s32
    s_and_b32 s3, s4, 0xffff
    s_cbranch_scc1 L_vl2a
L_vd2a:
    s_mov_b64 s[32:33], s[54:55]
    s_mov_b64 s[34:35], s[54:55]
    s_mov_b64 s[36:37], s[54:55]
    s_mov_b64 s[38:39], s[54:55]
    s_mov_b64 s[56:57], s[54:55]
    s_mov_b64 s[58:59], s[54:55]
    s_mov_b64 s[60:61], s[54:55]
    s_mov_b64 s[62:63], s[54:55]
    s_setpc_b64 s[0:1]
L_nr2a:
    s_add_u32 s69, s69, 1
    s_cmp_gt_u32 s69, 262144
    s_cbranch_scc1 L_nok2a
    buffer_load_dword v41, off, s[60:63], 0 sc1
    s_waitcnt vmcnt(0)
    v_readfirstlane_b32 s68, v41
    s_cmp_eq_u32 s68, 0
    s_cbranch_scc1 L_nr2a
    s_branch L_nok2a
L_c2a_a10:
    s_call_b64 s[0:1], L_vp2a
    s_branch L_g2a_a10
L_c2a_a12:
    s_call_b64 s[0:1], L_vp2a
    s_branch L_g2a_a12
L_c2a_a14:
    s_call_b64 s[0:1], L_vp2a
    s_branch L_g2a_a14
L_c2a_a16:
    s_call_b64 s[0:1], L_vp2a
    s_branch L_g2a_a16
L_c2a_d10:
    s_call_b64 s[0:1], L_vp2a
    s_branch L_g2a_d10
L_c2a_d12:
    s_call_b64 s[0:1], L_vp2a
    s_branch L_g2a_d12
L_c2a_d14:
    s_call_b64 s[0:1], L_vp2a
    s_branch L_g2a_d14
L_c2a_d16:
    s_call_b64 s[0:1], L_vp2a
    s_branch L_g2a_d16
L_nrc1:
    s_add_u32 s69, s69, 1
    s_cmp_gt_u32 s69, 262144
    s_cbranch_scc1 L_nokc1
    buffer_load_dword v18, off, s[60:63], 0 sc1
    s_waitcnt vmcnt(0)
    v_readfirstlane_b32 s23, v18
    s_cmp_eq_u32 s23, 0
    s_cbranch_scc1 L_nrc1
    s_branch L_nokc1
L_nrc2:
    s_add_u32 s69, s69, 1
    s_cmp_gt_u32 s69, 262144
    s_cbranch_scc1 L_nokc2
    buffer_load_dword v18, off, s[60:63], 0 sc1
    s_waitcnt vmcnt(0)
    v_readfirstlane_b32 s23, v18
    s_cmp_eq_u32 s23, 0
    s_cbranch_scc1 L_nrc2
    s_branch L_nokc2
L_pgend4:
.fill (17664 - (L_pgend4 - standalone__dense_activation_squared_relu__sampling_kernel)) / 4, 4, 0xbf800000
L_seg_c1_10:
    s_barrier
    ds_read_b128 v[204:207], v56 offset:24576
    v_mfma_f32_16x16x32_bf16 v[212:215], v[124:127], v[152:155], v[212:215]
    ds_read_b128 v[208:211], v56 offset:26624
    v_mfma_f32_16x16x32_bf16 v[216:219], v[128:131], v[152:155], v[216:219]
    ds_read_b128 v[60:63], v56 offset:25600
    v_mfma_f32_16x16x32_bf16 v[220:223], v[124:127], v[156:159], v[220:223]
    ds_read_b128 v[64:67], v56 offset:27648
    v_mfma_f32_16x16x32_bf16 v[224:227], v[128:131], v[156:159], v[224:227]
    s_waitcnt lgkmcnt(4)
    ds_read_b128 v[68:71], v56 offset:28672
    v_mfma_f32_16x16x32_bf16 v[228:231], v[124:127], v[160:163], v[228:231]
    ds_read_b128 v[72:75], v56 offset:30720
    v_mfma_f32_16x16x32_bf16 v[232:235], v[128:131], v[160:163], v[232:235]
    ds_read_b128 v[76:79], v56 offset:29696
    v_mfma_f32_16x16x32_bf16 v[236:239], v[124:127], v[164:167], v[236:239]
    ds_read_b128 v[100:103], v56 offset:31744
    v_mfma_f32_16x16x32_bf16 v[240:243], v[128:131], v[164:167], v[240:243]
    ds_read_b64_tr_b16 v[104:105], v48 offset:53248
    ds_read_b64_tr_b16 v[106:107], v48 offset:57344
    v_mfma_f32_16x16x32_bf16 v[244:247], v[124:127], v[168:171], v[244:247]
    ds_read_b64_tr_b16 v[80:81], v49 offset:53248
    ds_read_b64_tr_b16 v[82:83], v49 offset:57344
    v_mfma_f32_16x16x32_bf16 v[248:251], v[128:131], v[168:171], v[248:251]
    ds_read_b64_tr_b16 v[84:85], v48 offset:61440
    s_waitcnt lgkmcnt(10)
    v_mfma_f32_16x16x32_bf16 v[212:215], v[172:175], v[204:207], v[212:215]
    ds_read_b64_tr_b16 v[86:87], v50 offset:0
    ds_read_b64_tr_b16 v[88:89], v49 offset:61440
    v_mfma_f32_16x16x32_bf16 v[216:219], v[176:179], v[204:207], v[216:219]
    ds_read_b64_tr_b16 v[90:91], v51 offset:0
    v_mfma_f32_16x16x32_bf16 v[220:223], v[172:175], v[208:211], v[220:223]
    v_mfma_f32_16x16x32_bf16 v[224:227], v[176:179], v[208:211], v[224:227]
    s_waitcnt lgkmcnt(9)
    v_mfma_f32_16x16x32_bf16 v[212:215], v[180:183], v[60:63], v[212:215]
    v_mfma_f32_16x16x32_bf16 v[216:219], v[184:187], v[60:63], v[216:219]
    s_barrier
    ds_read_b128 v[92:95], v55 offset:30720
    v_mfma_f32_16x16x32_bf16 v[220:223], v[180:183], v[64:67], v[220:223]
    ds_read_b128 v[96:99], v55 offset:32768
    v_mfma_f32_16x16x32_bf16 v[224:227], v[184:187], v[64:67], v[224:227]
    ds_read_b128 v[108:111], v55 offset:31744
    v_mfma_f32_16x16x32_bf16 v[212:215], v[188:191], v[68:71], v[212:215]
    ds_read_b128 v[112:115], v55 offset:33792
    v_mfma_f32_16x16x32_bf16 v[216:219], v[192:195], v[68:71], v[216:219]
    s_waitcnt lgkmcnt(4)
    ds_read_b64_tr_b16 v[132:133], v50 offset:14336
    v_mfma_f32_16x16x32_bf16 v[220:223], v[188:191], v[72:75], v[220:223]
    ds_read_b64_tr_b16 v[134:135], v50 offset:18432
    ds_read_b64_tr_b16 v[136:137], v51 offset:14336
    v_mfma_f32_16x16x32_bf16 v[224:227], v[192:195], v[72:75], v[224:227]
    ds_read_b64_tr_b16 v[138:139], v51 offset:18432
    ds_read_b128 v[140:143], v55 offset:34816
    v_mfma_f32_16x16x32_bf16 v[212:215], v[196:199], v[76:79], v[212:215]
    ds_read_b128 v[144:147], v55 offset:36864
    v_mfma_f32_16x16x32_bf16 v[216:219], v[200:203], v[76:79], v[216:219]
    ds_read_b64_tr_b16 v[148:149], v50 offset:22528
    v_mfma_f32_16x16x32_bf16 v[220:223], v[196:199], v[100:103], v[220:223]
    ds_read_b64_tr_b16 v[150:151], v50 offset:26624
    ds_read_b64_tr_b16 v[116:117], v51 offset:22528
    v_mfma_f32_16x16x32_bf16 v[224:227], v[200:203], v[100:103], v[224:227]
    s_waitcnt lgkmcnt(10)
    v_mfma_f32_16x16x32_bf16 v[212:215], v[104:107], v[92:95], v[212:215]
    ds_read_b64_tr_b16 v[118:119], v51 offset:26624
    ds_read_b128 v[120:123], v55 offset:35840
    v_mfma_f32_16x16x32_bf16 v[216:219], v[80:83], v[92:95], v[216:219]
    ds_read_b128 v[152:155], v55 offset:37888
    v_mfma_f32_16x16x32_bf16 v[220:223], v[104:107], v[96:99], v[220:223]
    s_waitcnt lgkmcnt(9)
    ds_read_b64_tr_b16 v[156:157], v48 offset:0
    v_mfma_f32_16x16x32_bf16 v[224:227], v[80:83], v[96:99], v[224:227]
    ds_read_b64_tr_b16 v[158:159], v48 offset:4096
    ds_read_b64_tr_b16 v[160:161], v49 offset:0
    v_mfma_f32_16x16x32_bf16 v[212:215], v[84:87], v[108:111], v[212:215]
    ds_read_b64_tr_b16 v[162:163], v49 offset:4096
    v_mfma_f32_16x16x32_bf16 v[216:219], v[88:91], v[108:111], v[216:219]
    s_barrier
    s_waitcnt lgkmcnt(9)
    ds_read_b128 v[164:167], v55 offset:38912
    v_mfma_f32_16x16x32_bf16 v[220:223], v[84:87], v[112:115], v[220:223]
    ds_read_b128 v[168:171], v54 offset:16384
    v_mfma_f32_16x16x32_bf16 v[224:227], v[88:91], v[112:115], v[224:227]
    ds_read_b64_tr_b16 v[124:125], v48 offset:8192
    ds_read_b64_tr_b16 v[126:127], v48 offset:12288
    v_mfma_f32_16x16x32_bf16 v[212:215], v[132:135], v[140:143], v[212:215]
    s_waitcnt lgkmcnt(9)
    ds_read_b64_tr_b16 v[128:129], v49 offset:8192
    v_mfma_f32_16x16x32_bf16 v[216:219], v[136:139], v[140:143], v[216:219]
    ds_read_b64_tr_b16 v[130:131], v49 offset:12288
    ds_read_b128 v[204:207], v55 offset:39936
    v_mfma_f32_16x16x32_bf16 v[220:223], v[132:135], v[144:147], v[220:223]
    ds_read_b128 v[208:211], v54 offset:17408
    v_mfma_f32_16x16x32_bf16 v[224:227], v[136:139], v[144:147], v[224:227]
    s_waitcnt lgkmcnt(9)
    ds_read_b64_tr_b16 v[60:61], v50 offset:40960
    v_mfma_f32_16x16x32_bf16 v[212:215], v[148:151], v[120:123], v[212:215]
    ds_read_b64_tr_b16 v[62:63], v50 offset:45056
    ds_read_b64_tr_b16 v[64:65], v51 offset:40960
    v_mfma_f32_16x16x32_bf16 v[216:219], v[116:119], v[120:123], v[216:219]
    ds_read_b64_tr_b16 v[66:67], v51 offset:45056
    v_mfma_f32_16x16x32_bf16 v[220:223], v[148:151], v[152:155], v[220:223]
    v_mfma_f32_16x16x32_bf16 v[224:227], v[116:119], v[152:155], v[224:227]
    s_waitcnt lgkmcnt(8)
    v_mfma_f32_16x16x32_bf16 v[212:215], v[156:159], v[164:167], v[212:215]
    ds_read_b128 v[68:71], v54 offset:18432
    v_mfma_f32_16x16x32_bf16 v[216:219], v[160:163], v[164:167], v[216:219]
    ds_read_b128 v[72:75], v54 offset:20480
    v_mfma_f32_16x16x32_bf16 v[220:223], v[156:159], v[168:171], v[220:223]
    ds_read_b64_tr_b16 v[76:77], v50 offset:49152
    ds_read_b64_tr_b16 v[78:79], v50 offset:53248
    v_mfma_f32_16x16x32_bf16 v[224:227], v[160:163], v[168:171], v[224:227]
    ds_read_b64_tr_b16 v[100:101], v51 offset:49152
    s_waitcnt lgkmcnt(8)
    v_mfma_f32_16x16x32_bf16 v[212:215], v[124:127], v[204:207], v[212:215]
    ds_read_b64_tr_b16 v[102:103], v51 offset:53248
    ds_read_b128 v[92:95], v54 offset:19456
    v_mfma_f32_16x16x32_bf16 v[216:219], v[128:131], v[204:207], v[216:219]
    s_barrier
    ds_read_b128 v[96:99], v54 offset:21504
    v_mfma_f32_16x16x32_bf16 v[220:223], v[124:127], v[208:211], v[220:223]
    ds_read_b64_tr_b16 v[108:109], v50 offset:57344
    v_mfma_f32_16x16x32_bf16 v[224:227], v[128:131], v[208:211], v[224:227]
    ds_read_b64_tr_b16 v[110:111], v50 offset:61440
    s_waitcnt lgkmcnt(9)
    v_mfma_f32_16x16x32_bf16 v[212:215], v[60:63], v[68:71], v[212:215]
    ds_read_b64_tr_b16 v[112:113], v51 offset:57344
    ds_read_b64_tr_b16 v[114:115], v51 offset:61440
    v_mfma_f32_16x16x32_bf16 v[216:219], v[64:67], v[68:71], v[216:219]
    ds_read_b128 v[140:143], v54 offset:22528
    s_waitcnt lgkmcnt(11)
    v_mfma_f32_16x16x32_bf16 v[220:223], v[60:63], v[72:75], v[220:223]
    ds_read_b128 v[144:147], v54 offset:24576
    v_mfma_f32_16x16x32_bf16 v[224:227], v[64:67], v[72:75], v[224:227]
    ds_read_b64_tr_b16 v[120:121], v52 offset:0
    s_waitcnt lgkmcnt(8)
    v_mfma_f32_16x16x32_bf16 v[212:215], v[76:79], v[92:95], v[212:215]
    ds_read_b64_tr_b16 v[122:123], v52 offset:4096
    ds_read_b64_tr_b16 v[152:153], v53 offset:0
    v_mfma_f32_16x16x32_bf16 v[216:219], v[100:103], v[92:95], v[216:219]
    ds_read_b64_tr_b16 v[154:155], v53 offset:4096
    s_waitcnt lgkmcnt(10)
    v_mfma_f32_16x16x32_bf16 v[220:223], v[76:79], v[96:99], v[220:223]
    ds_read_b128 v[164:167], v54 offset:23552
    v_mfma_f32_16x16x32_bf16 v[224:227], v[100:103], v[96:99], v[224:227]
    ds_read_b128 v[168:171], v54 offset:25600
    s_waitcnt lgkmcnt(7)
    v_mfma_f32_16x16x32_bf16 v[212:215], v[108:111], v[140:143], v[212:215]
    ds_read_b128 v[204:207], v54 offset:43008
    v_mfma_f32_16x16x32_bf16 v[216:219], v[112:115], v[140:143], v[216:219]
    ds_read_b128 v[208:211], v54 offset:44032
    s_waitcnt lgkmcnt(8)
    v_mfma_f32_16x16x32_bf16 v[220:223], v[108:111], v[144:147], v[220:223]
    ds_read_b128 v[68:71], v54 offset:45056
    v_mfma_f32_16x16x32_bf16 v[224:227], v[112:115], v[144:147], v[224:227]
    ds_read_b128 v[72:75], v54 offset:46080
    s_waitcnt lgkmcnt(5)
    v_mfma_f32_16x16x32_bf16 v[212:215], v[120:123], v[164:167], v[212:215]
    ds_read_b128 v[92:95], v54 offset:47104
    v_mfma_f32_16x16x32_bf16 v[216:219], v[152:155], v[164:167], v[216:219]
    ds_read_b128 v[96:99], v54 offset:48128
    s_waitcnt lgkmcnt(6)
    v_mfma_f32_16x16x32_bf16 v[220:223], v[120:123], v[168:171], v[220:223]
    ds_read_b128 v[140:143], v54 offset:49152
    v_mfma_f32_16x16x32_bf16 v[224:227], v[152:155], v[168:171], v[224:227]
    ds_read_b128 v[144:147], v54 offset:50176
    s_waitcnt lgkmcnt(7)
    v_mfma_f32_16x16x32_bf16 v[228:231], v[172:175], v[204:207], v[228:231]
    v_mfma_f32_16x16x32_bf16 v[232:235], v[176:179], v[204:207], v[232:235]
    s_waitcnt lgkmcnt(6)
    v_mfma_f32_16x16x32_bf16 v[228:231], v[180:183], v[208:211], v[228:231]
    v_mfma_f32_16x16x32_bf16 v[232:235], v[184:187], v[208:211], v[232:235]
    v_perm_b32 v24, v213, v212, s19
    s_waitcnt lgkmcnt(4)
    v_mfma_f32_16x16x32_bf16 v[228:231], v[188:191], v[68:71], v[228:231]
    v_perm_b32 v25, v215, v214, s19
    v_perm_b32 v26, v221, v220, s19
    v_mfma_f32_16x16x32_bf16 v[232:235], v[192:195], v[68:71], v[232:235]
    s_barrier
    v_perm_b32 v27, v223, v222, s19
    v_bfi_b32 v24, s20, v20, v24
    v_mfma_f32_16x16x32_bf16 v[228:231], v[196:199], v[72:75], v[228:231]
    v_bfi_b32 v25, s20, v21, v25
    v_bfi_b32 v26, s20, v22, v26
    v_mfma_f32_16x16x32_bf16 v[232:235], v[200:203], v[72:75], v[232:235]
    v_bfi_b32 v27, s20, v23, v27
    s_waitcnt lgkmcnt(0)
    v_mfma_f32_16x16x32_bf16 v[228:231], v[104:107], v[92:95], v[228:231]
    ds_read_b128 v[164:167], v54 offset:51200
    buffer_store_dwordx4 v[24:27], v14, s[44:47], s16 offen offset:0 sc1
    v_mfma_f32_16x16x32_bf16 v[232:235], v[80:83], v[92:95], v[232:235]
    v_perm_b32 v28, v217, v216, s19
    v_perm_b32 v29, v219, v218, s19
    v_mfma_f32_16x16x32_bf16 v[228:231], v[84:87], v[96:99], v[228:231]
    ds_read_b128 v[168:171], v54 offset:52224
    v_perm_b32 v30, v225, v224, s19
    v_mfma_f32_16x16x32_bf16 v[232:235], v[88:91], v[96:99], v[232:235]
    v_perm_b32 v31, v227, v226, s19
    v_bfi_b32 v28, s20, v20, v28
    v_mfma_f32_16x16x32_bf16 v[228:231], v[132:135], v[140:143], v[228:231]
    ds_read_b128 v[204:207], v55 offset:4096
    v_bfi_b32 v29, s20, v21, v29
    v_mfma_f32_16x16x32_bf16 v[232:235], v[136:139], v[140:143], v[232:235]
    v_bfi_b32 v30, s20, v22, v30
    v_bfi_b32 v31, s20, v23, v31
    v_mfma_f32_16x16x32_bf16 v[228:231], v[148:151], v[144:147], v[228:231]
    ds_read_b128 v[208:211], v55 offset:5120
    buffer_store_dwordx4 v[28:31], v14, s[44:47], s17 offen offset:0 sc1
    v_mfma_f32_16x16x32_bf16 v[232:235], v[116:119], v[144:147], v[232:235]
    s_cmp_eq_u32 s7, 6
    s_cbranch_scc1 L_cx1
    s_waitcnt lgkmcnt(3)
    v_mfma_f32_16x16x32_bf16 v[228:231], v[156:159], v[164:167], v[228:231]
    ds_read_b128 v[68:71], v55 offset:6144
    v_mfma_f32_16x16x32_bf16 v[232:235], v[160:163], v[164:167], v[232:235]
    ds_read_b128 v[72:75], v55 offset:7168
    s_waitcnt lgkmcnt(4)
    v_mfma_f32_16x16x32_bf16 v[228:231], v[124:127], v[168:171], v[228:231]
    ds_read_b128 v[92:95], v55 offset:8192
    v_mfma_f32_16x16x32_bf16 v[232:235], v[128:131], v[168:171], v[232:235]
    ds_read_b128 v[96:99], v55 offset:9216
    s_waitcnt lgkmcnt(5)
    v_mfma_f32_16x16x32_bf16 v[228:231], v[60:63], v[204:207], v[228:231]
    ds_read_b128 v[140:143], v55 offset:10240
    v_mfma_f32_16x16x32_bf16 v[232:235], v[64:67], v[204:207], v[232:235]
    ds_read_b128 v[144:147], v55 offset:11264
    s_waitcnt lgkmcnt(6)
    v_mfma_f32_16x16x32_bf16 v[228:231], v[76:79], v[208:211], v[228:231]
    ds_read_b128 v[164:167], v55 offset:12288
    v_mfma_f32_16x16x32_bf16 v[232:235], v[100:103], v[208:211], v[232:235]
    ds_read_b128 v[168:171], v55 offset:13312
    s_waitcnt lgkmcnt(7)
    v_mfma_f32_16x16x32_bf16 v[228:231], v[108:111], v[68:71], v[228:231]
    ds_read_b128 v[204:207], v56 offset:8192
    v_mfma_f32_16x16x32_bf16 v[232:235], v[112:115], v[68:71], v[232:235]
    ds_read_b128 v[208:211], v56 offset:9216
    s_waitcnt lgkmcnt(8)
    v_mfma_f32_16x16x32_bf16 v[228:231], v[120:123], v[72:75], v[228:231]
    ds_read_b128 v[68:71], v56 offset:10240
    v_mfma_f32_16x16x32_bf16 v[232:235], v[152:155], v[72:75], v[232:235]
    ds_read_b128 v[72:75], v56 offset:11264
    s_waitcnt lgkmcnt(8)
    v_mfma_f32_16x16x32_bf16 v[236:239], v[172:175], v[92:95], v[236:239]
    v_mfma_f32_16x16x32_bf16 v[240:243], v[176:179], v[92:95], v[240:243]
    ds_read_b128 v[92:95], v56 offset:12288
    v_mfma_f32_16x16x32_bf16 v[236:239], v[180:183], v[96:99], v[236:239]
    v_mfma_f32_16x16x32_bf16 v[240:243], v[184:187], v[96:99], v[240:243]
    v_perm_b32 v32, v229, v228, s19
    s_waitcnt lgkmcnt(5)
    v_mfma_f32_16x16x32_bf16 v[236:239], v[188:191], v[140:143], v[236:239]
    v_perm_b32 v33, v231, v230, s19
    v_perm_b32 v34, v233, v232, s19
    v_mfma_f32_16x16x32_bf16 v[240:243], v[192:195], v[140:143], v[240:243]
    v_perm_b32 v35, v235, v234, s19
    v_bfi_b32 v32, s20, v20, v32
    v_mfma_f32_16x16x32_bf16 v[236:239], v[196:199], v[144:147], v[236:239]
    v_bfi_b32 v33, s20, v21, v33
    v_bfi_b32 v34, s20, v22, v34
    v_mfma_f32_16x16x32_bf16 v[240:243], v[200:203], v[144:147], v[240:243]
    v_bfi_b32 v35, s20, v23, v35
    buffer_store_dwordx4 v[32:35], v19, s[44:47], s16 offen offset:1024 sc1
    v_mfma_f32_16x16x32_bf16 v[236:239], v[104:107], v[164:167], v[236:239]
    ds_read_b128 v[96:99], v56 offset:13312
    v_mfma_f32_16x16x32_bf16 v[240:243], v[80:83], v[164:167], v[240:243]
    ds_read_b128 v[140:143], v56 offset:14336
    v_mfma_f32_16x16x32_bf16 v[236:239], v[84:87], v[168:171], v[236:239]
    ds_read_b128 v[144:147], v56 offset:15360
    v_mfma_f32_16x16x32_bf16 v[240:243], v[88:91], v[168:171], v[240:243]
    s_waitcnt lgkmcnt(3)
    v_mfma_f32_16x16x32_bf16 v[236:239], v[132:135], v[204:207], v[236:239]
    v_mfma_f32_16x16x32_bf16 v[240:243], v[136:139], v[204:207], v[240:243]
    v_mfma_f32_16x16x32_bf16 v[236:239], v[148:151], v[208:211], v[236:239]
    v_mfma_f32_16x16x32_bf16 v[240:243], v[116:119], v[208:211], v[240:243]
    v_mfma_f32_16x16x32_bf16 v[236:239], v[156:159], v[68:71], v[236:239]
    v_mfma_f32_16x16x32_bf16 v[240:243], v[160:163], v[68:71], v[240:243]
    s_barrier
    ds_read_b128 v[164:167], v56 offset:16384
    v_mfma_f32_16x16x32_bf16 v[236:239], v[124:127], v[72:75], v[236:239]
    ds_read_b128 v[168:171], v56 offset:17408
    v_mfma_f32_16x16x32_bf16 v[240:243], v[128:131], v[72:75], v[240:243]
    ds_read_b128 v[204:207], v56 offset:18432
    v_mfma_f32_16x16x32_bf16 v[236:239], v[60:63], v[92:95], v[236:239]
    ds_read_b128 v[208:211], v56 offset:19456
    v_mfma_f32_16x16x32_bf16 v[240:243], v[64:67], v[92:95], v[240:243]
    ds_read_b128 v[68:71], v56 offset:20480
    s_waitcnt lgkmcnt(5)
    v_mfma_f32_16x16x32_bf16 v[236:239], v[76:79], v[96:99], v[236:239]
    ds_read_b128 v[72:75], v56 offset:21504
    v_mfma_f32_16x16x32_bf16 v[240:243], v[100:103], v[96:99], v[240:243]
    ds_read_b128 v[92:95], v56 offset:22528
    v_mfma_f32_16x16x32_bf16 v[236:239], v[108:111], v[140:143], v[236:239]
    ds_read_b128 v[96:99], v56 offset:23552
    v_mfma_f32_16x16x32_bf16 v[240:243], v[112:115], v[140:143], v[240:243]
    ds_read_b128 v[140:143], v54 offset:26624
    v_mfma_f32_16x16x32_bf16 v[236:239], v[120:123], v[144:147], v[236:239]
    v_mfma_f32_16x16x32_bf16 v[240:243], v[152:155], v[144:147], v[240:243]
    ds_read_b128 v[144:147], v54 offset:27648
    s_waitcnt lgkmcnt(7)
    v_mfma_f32_16x16x32_bf16 v[244:247], v[172:175], v[164:167], v[244:247]
    v_mfma_f32_16x16x32_bf16 v[248:251], v[176:179], v[164:167], v[248:251]
    ds_read_b128 v[164:167], v54 offset:28672
    v_mfma_f32_16x16x32_bf16 v[244:247], v[180:183], v[168:171], v[244:247]
    ds_read_b128 v[172:175], v54 offset:29696
    v_mfma_f32_16x16x32_bf16 v[248:251], v[184:187], v[168:171], v[248:251]
    v_perm_b32 v36, v237, v236, s19
    v_perm_b32 v37, v239, v238, s19
    v_mfma_f32_16x16x32_bf16 v[244:247], v[188:191], v[204:207], v[244:247]
    v_perm_b32 v38, v241, v240, s19
    v_perm_b32 v39, v243, v242, s19
    v_mfma_f32_16x16x32_bf16 v[248:251], v[192:195], v[204:207], v[248:251]
    v_bfi_b32 v36, s20, v20, v36
    s_waitcnt lgkmcnt(3)
    v_mfma_f32_16x16x32_bf16 v[244:247], v[196:199], v[208:211], v[244:247]
    v_bfi_b32 v37, s20, v21, v37
    v_bfi_b32 v38, s20, v22, v38
    v_mfma_f32_16x16x32_bf16 v[248:251], v[200:203], v[208:211], v[248:251]
    v_bfi_b32 v39, s20, v23, v39
    buffer_store_dwordx4 v[36:39], v19, s[44:47], s16 offen offset:1536 sc1
    v_mfma_f32_16x16x32_bf16 v[244:247], v[104:107], v[68:71], v[244:247]
    ds_read_b128 v[176:179], v54 offset:30720
    v_mfma_f32_16x16x32_bf16 v[248:251], v[80:83], v[68:71], v[248:251]
    ds_read_b128 v[168:171], v54 offset:31744
    v_mfma_f32_16x16x32_bf16 v[244:247], v[84:87], v[72:75], v[244:247]
    v_mfma_f32_16x16x32_bf16 v[248:251], v[88:91], v[72:75], v[248:251]
    v_mfma_f32_16x16x32_bf16 v[244:247], v[132:135], v[92:95], v[244:247]
    v_mfma_f32_16x16x32_bf16 v[248:251], v[136:139], v[92:95], v[248:251]
    v_mfma_f32_16x16x32_bf16 v[244:247], v[148:151], v[96:99], v[244:247]
    v_mfma_f32_16x16x32_bf16 v[248:251], v[116:119], v[96:99], v[248:251]
    v_mfma_f32_16x16x32_bf16 v[244:247], v[156:159], v[140:143], v[244:247]
    v_mfma_f32_16x16x32_bf16 v[248:251], v[160:163], v[140:143], v[248:251]
    s_waitcnt lgkmcnt(0)
    v_mfma_f32_16x16x32_bf16 v[244:247], v[124:127], v[144:147], v[244:247]
    v_mfma_f32_16x16x32_bf16 v[248:251], v[128:131], v[144:147], v[248:251]
    v_mfma_f32_16x16x32_bf16 v[244:247], v[60:63], v[164:167], v[244:247]
    v_mfma_f32_16x16x32_bf16 v[248:251], v[64:67], v[164:167], v[248:251]
    v_mfma_f32_16x16x32_bf16 v[244:247], v[76:79], v[172:175], v[244:247]
    v_mfma_f32_16x16x32_bf16 v[248:251], v[100:103], v[172:175], v[248:251]
    v_mfma_f32_16x16x32_bf16 v[244:247], v[108:111], v[176:179], v[244:247]
    v_mfma_f32_16x16x32_bf16 v[248:251], v[112:115], v[176:179], v[248:251]
    v_mfma_f32_16x16x32_bf16 v[244:247], v[120:123], v[168:171], v[244:247]
    v_mfma_f32_16x16x32_bf16 v[248:251], v[152:155], v[168:171], v[248:251]
    s_nop 7
    v_perm_b32 v40, v245, v244, s19
    v_perm_b32 v41, v247, v246, s19
    v_perm_b32 v42, v249, v248, s19
    v_perm_b32 v43, v251, v250, s19
    v_bfi_b32 v40, s20, v20, v40
    v_bfi_b32 v41, s20, v21, v41
    v_bfi_b32 v42, s20, v22, v42
    v_bfi_b32 v43, s20, v23, v43
    buffer_store_dwordx4 v[40:43], v19, s[44:47], s16 offen offset:2048 sc1
L_cx1:
    s_endpgm
L_seg_f2:
    s_waitcnt vmcnt(8)
    s_barrier
    s_and_b32 m0, s21, 6
    s_branch L_g2a_a14
L_q2a_a14:
    s_add_u32 s68, s68, 1
    s_cmp_gt_u32 s68, 15
    s_cbranch_scc1 L_c2a_a14
    s_load_dwordx8 s[32:39], s[52:53], s10
    s_load_dwordx8 s[56:63], s[52:53], s11
    s_add_u32 s52, s52, 1024
    s_addc_u32 s53, s53, 0
    s_waitcnt lgkmcnt(0)
L_g2a_a14:
    s_movrels_b64 vcc, s[32:33]
    s_cmp_lg_u64 vcc, s[54:55]
    s_cbranch_scc1 L_q2a_a14
    s_movrels_b64 vcc, s[56:57]
    s_cmp_lg_u64 vcc, s[54:55]
    s_cbranch_scc1 L_q2a_a14
    s_add_u32 m0, s31, 90112
    s_nop 0
    buffer_load_dwordx4 v6, s[44:47], s97 offen sc1 lds
    s_add_u32 m0, s31, 92160
    s_nop 0
    buffer_load_dwordx4 v7, s[44:47], s97 offen sc1 lds
    s_add_u32 m0, s31, 0
    s_nop 0
    buffer_load_dwordx4 v6, s[44:47], s98 offen sc1 lds
    s_add_u32 m0, s31, 2048
    s_nop 0
    buffer_load_dwordx4 v7, s[44:47], s98 offen sc1 lds
    s_and_b32 m0, s23, 6
    s_branch L_g2a_a16
L_q2a_a16:
    s_add_u32 s68, s68, 1
    s_cmp_gt_u32 s68, 15
    s_cbranch_scc1 L_c2a_a16
    s_load_dwordx8 s[32:39], s[52:53], s10
    s_load_dwordx8 s[56:63], s[52:53], s11
    s_add_u32 s52, s52, 1024
    s_addc_u32 s53, s53, 0
    s_waitcnt lgkmcnt(0)
L_g2a_a16:
    s_movrels_b64 vcc, s[32:33]
    s_cmp_lg_u64 vcc, s[54:55]
    s_cbranch_scc1 L_q2a_a16
    s_movrels_b64 vcc, s[56:57]
    s_cmp_lg_u64 vcc, s[54:55]
    s_cbranch_scc1 L_q2a_a16
    s_add_u32 m0, s31, 8192
    s_nop 0
    buffer_load_dwordx4 v6, s[44:47], s99 offen sc1 lds
    s_add_u32 m0, s31, 10240
    s_nop 0
    buffer_load_dwordx4 v7, s[44:47], s99 offen sc1 lds
    s_add_u32 m0, s31, 16384
    s_waitcnt vmcnt(13)
    buffer_load_dwordx4 v6, s[44:47], s100 offen sc1 lds
    s_add_u32 m0, s31, 18432
    s_waitcnt vmcnt(13)
    buffer_load_dwordx4 v7, s[44:47], s100 offen sc1 lds
    s_waitcnt vmcnt(12)
    s_barrier
    s_mov_b32 s10, s13
    s_mov_b32 s11, s15
    s_mov_b64 s[32:33], 0
    s_mov_b64 s[34:35], 0
    s_mov_b64 s[36:37], 0
    s_mov_b64 s[38:39], 0
    s_mov_b64 s[56:57], 0
    s_mov_b64 s[58:59], 0
    s_mov_b64 s[60:61], 0
    s_mov_b64 s[62:63], 0
    s_and_b32 m0, s17, 6
    s_branch L_g2a_d10
L_q2a_d10:
    s_add_u32 s68, s68, 1
    s_cmp_gt_u32 s68, 15
    s_cbranch_scc1 L_c2a_d10
    s_load_dwordx8 s[32:39], s[52:53], s10
    s_load_dwordx8 s[56:63], s[52:53], s11
    s_add_u32 s52, s52, 1024
    s_addc_u32 s53, s53, 0
    s_waitcnt lgkmcnt(0)
L_g2a_d10:
    s_movrels_b64 vcc, s[32:33]
    s_cmp_lg_u64 vcc, s[54:55]
    s_cbranch_scc1 L_q2a_d10
    s_movrels_b64 vcc, s[56:57]
    s_cmp_lg_u64 vcc, s[54:55]
    s_cbranch_scc1 L_q2a_d10
    s_add_u32 m0, s31, 32768
    s_nop 0
    buffer_load_dwordx4 v8, s[44:47], s93 offen sc1 lds
    s_add_u32 m0, s31, 40960
    s_nop 0
    buffer_load_dwordx4 v8, s[44:47], s94 offen sc1 lds
    s_and_b32 m0, s19, 6
    s_branch L_g2a_d12
L_q2a_d12:
    s_add_u32 s68, s68, 1
    s_cmp_gt_u32 s68, 15
    s_cbranch_scc1 L_c2a_d12
    s_load_dwordx8 s[32:39], s[52:53], s10
    s_load_dwordx8 s[56:63], s[52:53], s11
    s_add_u32 s52, s52, 1024
    s_addc_u32 s53, s53, 0
    s_waitcnt lgkmcnt(0)
L_g2a_d12:
    s_movrels_b64 vcc, s[32:33]
    s_cmp_lg_u64 vcc, s[54:55]
    s_cbranch_scc1 L_q2a_d12
    s_movrels_b64 vcc, s[56:57]
    s_cmp_lg_u64 vcc, s[54:55]
    s_cbranch_scc1 L_q2a_d12
    s_add_u32 m0, s31, 98304
    s_waitcnt vmcnt(13)
    buffer_load_dwordx4 v8, s[44:47], s95 offen sc1 lds
    s_add_u32 m0, s31, 106496
    s_waitcnt vmcnt(13)
    buffer_load_dwordx4 v8, s[44:47], s96 offen sc1 lds
    s_and_b32 m0, s21, 6
    s_branch L_g2a_d14
L_q2a_d14:
    s_add_u32 s68, s68, 1
    s_cmp_gt_u32 s68, 15
    s_cbranch_scc1 L_c2a_d14
    s_load_dwordx8 s[32:39], s[52:53], s10
    s_load_dwordx8 s[56:63], s[52:53], s11
    s_add_u32 s52, s52, 1024
    s_addc_u32 s53, s53, 0
    s_waitcnt lgkmcnt(0)
L_g2a_d14:
    s_movrels_b64 vcc, s[32:33]
    s_cmp_lg_u64 vcc, s[54:55]
    s_cbranch_scc1 L_q2a_d14
    s_movrels_b64 vcc, s[56:57]
    s_cmp_lg_u64 vcc, s[54:55]
    s_cbranch_scc1 L_q2a_d14
    s_add_u32 m0, s31, 114688
    s_waitcnt vmcnt(13)
    buffer_load_dwordx4 v8, s[44:47], s97 offen sc1 lds
    s_add_u32 m0, s31, 122880
    s_waitcnt vmcnt(13)
    buffer_load_dwordx4 v8, s[44:47], s98 offen sc1 lds
    s_barrier
    s_and_b32 m0, s23, 6
    s_branch L_g2a_d16
L_q2a_d16:
    s_add_u32 s68, s68, 1
    s_cmp_gt_u32 s68, 15
    s_cbranch_scc1 L_c2a_d16
    s_load_dwordx8 s[32:39], s[52:53], s10
    s_load_dwordx8 s[56:63], s[52:53], s11
    s_add_u32 s52, s52, 1024
    s_addc_u32 s53, s53, 0
    s_waitcnt lgkmcnt(0)
L_g2a_d16:
    s_movrels_b64 vcc, s[32:33]
    s_cmp_lg_u64 vcc, s[54:55]
    s_cbranch_scc1 L_q2a_d16
    s_movrels_b64 vcc, s[56:57]
    s_cmp_lg_u64 vcc, s[54:55]
    s_cbranch_scc1 L_q2a_d16
    s_add_u32 m0, s31, 131072
    s_waitcnt vmcnt(13)
    buffer_load_dwordx4 v8, s[44:47], s99 offen sc1 lds
    s_add_u32 m0, s31, 139264
    s_waitcnt vmcnt(13)
    buffer_load_dwordx4 v8, s[44:47], s100 offen sc1 lds
    s_add_u32 m0, s31, 34816
    s_waitcnt vmcnt(13)
    buffer_load_dwordx4 v9, s[44:47], s93 offen sc1 lds
    s_add_u32 m0, s31, 43008
    s_waitcnt vmcnt(13)
    buffer_load_dwordx4 v9, s[44:47], s94 offen sc1 lds
    s_barrier
    s_add_u32 m0, s31, 100352
    s_waitcnt vmcnt(13)
    buffer_load_dwordx4 v9, s[44:47], s95 offen sc1 lds
    s_add_u32 m0, s31, 108544
    s_waitcnt vmcnt(13)
    buffer_load_dwordx4 v9, s[44:47], s96 offen sc1 lds
    s_add_u32 m0, s31, 116736
    s_waitcnt vmcnt(13)
    buffer_load_dwordx4 v9, s[44:47], s97 offen sc1 lds
    s_add_u32 m0, s31, 124928
    s_waitcnt vmcnt(13)
    buffer_load_dwordx4 v9, s[44:47], s98 offen sc1 lds
    s_barrier
    s_add_u32 m0, s31, 133120
    s_waitcnt vmcnt(13)
    buffer_load_dwordx4 v9, s[44:47], s99 offen sc1 lds
    s_add_u32 m0, s31, 141312
    s_waitcnt vmcnt(13)
    buffer_load_dwordx4 v9, s[44:47], s100 offen sc1 lds
    s_waitcnt vmcnt(8)
    s_barrier
    s_waitcnt vmcnt(4)
    s_barrier
    s_waitcnt vmcnt(0)
    s_barrier
L_lx2a:
    s_mul_i32 s3, s6, 164096
    s_mul_i32 s26, s5, 20480
    s_add_u32 s26, s26, s3
    s_add_u32 s26, s26, 23068672
    s_mov_b32 s69, 0
    s_mov_b32 s27, 0x10001
    s_cmp_eq_u32 s9, 3
    s_cbranch_scc0 L_go2
    s_endpgm
L_go2:
    s_xor_b32 s3, s5, 0
    s_mul_i32 s3, s3, 2560
    s_add_u32 s16, s26, s3
    s_xor_b32 s3, s5, 1
    s_mul_i32 s3, s3, 2560
    s_add_u32 s17, s26, s3
    s_xor_b32 s3, s5, 2
    s_mul_i32 s3, s3, 2560
    s_add_u32 s18, s26, s3
    s_xor_b32 s3, s5, 3
    s_mul_i32 s3, s3, 2560
    s_add_u32 s19, s26, s3
    s_xor_b32 s3, s5, 4
    s_mul_i32 s3, s3, 2560
    s_add_u32 s20, s26, s3
    s_xor_b32 s3, s5, 5
    s_mul_i32 s3, s3, 2560
    s_add_u32 s21, s26, s3
    s_xor_b32 s3, s5, 6
    s_mul_i32 s3, s3, 2560
    s_add_u32 s22, s26, s3
    s_xor_b32 s3, s5, 7
    s_mul_i32 s3, s3, 2560
    s_add_u32 s23, s26, s3
    s_lshl_b32 s4, s8, 1
    s_lshr_b32 s3, s5, 2
    s_add_u32 s4, s4, s3
    s_mul_i32 s3, s4, 73728
    s_add_u32 s30, s30, s3
    s_lshl_b32 s4, s4, 1
    s_lshr_b32 s4, 37092, s4
    s_add_u32 s4, s4, s9
    s_add_u32 s3, s4, 1
    s_and_b32 s3, s3, 3
    s_mul_i32 s31, s3, 18432
    s_add_u32 s31, s31, s30
    s_and_b32 s4, s4, 3
    s_mul_i32 s4, s4, 18432
    s_add_u32 s30, s30, s4
    s_cmp_eq_u32 s9, 0
    s_cbranch_scc1 L_t2_1a
    s_mov_b32 s30, s31
    s_lshl_b32 s3, s9, 9
    s_add_u32 s26, s26, s3
    s_add_u32 s16, s26, 512
    s_add_u32 s17, s26, 5632
    s_add_u32 s18, s26, 10752
    s_add_u32 s19, s26, 15872
    s_branch L_t2_1b
L_pgend5:
.fill (21760 - (L_pgend5 - standalone__dense_activation_squared_relu__sampling_kernel)) / 4, 4, 0xbf800000
L_seg_f1a:
L_lx1a:
    s_cmp_lg_u32 s9, 0
    s_cbranch_scc1 L_lx1b
    v_and_b32 v36, 15, v2
    v_lshrrev_b32 v37, 2, v36
    v_xor_b32 v37, v37, v33
    v_and_b32 v38, 1, v2
    v_lshlrev_b32 v38, 4, v38
    v_mov_b32 v39, 0x3f80
    v_lshlrev_b32 v38, v38, v39
    v_bfe_u32 v39, v2, 1, 1
    v_lshl_or_b32 v37, v37, 1, v39
    v_mul_u32_u24 v36, 1152, v36
    v_add_u32 v58, v36, v40
    v_cmp_eq_u32 vcc, 0, v37
    v_mov_b32 v52, 0
    v_mov_b32 v56, 0
    v_cndmask_b32 v54, 0, v38, vcc
    v_cmp_eq_u32 vcc, 1, v37
    v_mov_b32 v53, 0
    v_mov_b32 v57, 0
    v_cndmask_b32 v55, 0, v38, vcc
    v_lshlrev_b32 v24, 16, v46
    v_and_b32 v25, 0xffff0000, v46
    v_lshlrev_b32 v26, 16, v47
    v_and_b32 v27, 0xffff0000, v47
    v_mov_b32 v28, v24
    v_mov_b32 v29, v25
    v_mov_b32 v30, v26
    v_mov_b32 v31, v27
    v_and_b32 v64, 3, v2
    v_lshlrev_b32 v64, 3, v64
    v_lshrrev_b32 v64, v64, v41
    v_bfe_u32 v65, v64, 0, 1
    v_bfe_u32 v66, v64, 1, 1
    v_lshl_or_b32 v20, v66, 16, v65
    v_bfe_u32 v65, v64, 2, 1
    v_bfe_u32 v66, v64, 3, 1
    v_lshl_or_b32 v21, v66, 16, v65
    v_bfe_u32 v65, v64, 4, 1
    v_bfe_u32 v66, v64, 5, 1
    v_lshl_or_b32 v22, v66, 16, v65
    v_bfe_u32 v65, v64, 6, 1
    v_bfe_u32 v66, v64, 7, 1
    v_lshl_or_b32 v23, v66, 16, v65
    v_xor_b32 v48, 0x10001, v20
    v_xor_b32 v49, 0x10001, v21
    v_xor_b32 v50, 0x10001, v22
    v_xor_b32 v51, 0x10001, v23
    s_mul_i32 s3, s6, 164096
    s_mul_i32 s26, s5, 20480
    s_add_u32 s26, s26, s3
    s_add_u32 s26, s26, 23068672
    s_mov_b32 s69, 0
    s_mov_b32 s27, 0x10001
    s_mov_b32 s28, 1
    s_xor_b32 s3, s5, 0
    s_mul_i32 s3, s3, 2560
    s_add_u32 s16, s26, s3
    s_xor_b32 s3, s5, 1
    s_mul_i32 s3, s3, 2560
    s_add_u32 s17, s26, s3
    s_xor_b32 s3, s5, 2
    s_mul_i32 s3, s3, 2560
    s_add_u32 s18, s26, s3
    s_xor_b32 s3, s5, 3
    s_mul_i32 s3, s3, 2560
    s_add_u32 s19, s26, s3
    s_xor_b32 s3, s5, 4
    s_mul_i32 s3, s3, 2560
    s_add_u32 s20, s26, s3
    s_xor_b32 s3, s5, 5
    s_mul_i32 s3, s3, 2560
    s_add_u32 s21, s26, s3
    s_xor_b32 s3, s5, 6
    s_mul_i32 s3, s3, 2560
    s_add_u32 s22, s26, s3
    s_xor_b32 s3, s5, 7
    s_mul_i32 s3, s3, 2560
    s_add_u32 s23, s26, s3
    s_mul_i32 s4, s7, 80
    s_mul_i32 s4, s4, 1152
    s_add_u32 s30, s30, s4
    s_add_u32 s31, s30, 18432
    s_waitcnt vmcnt(0)
    s_barrier
    s_cmp_eq_u32 s28, 0
    s_cbranch_scc1 L_fx1a
    s_sleep 4
    s_cmp_lg_u32 s7, 6
    s_cbranch_scc1 L_p31a
    s_sleep 10
L_p31a:
    s_branch L_poll1a
L_t2_1a:
    s_sleep 2
L_poll1a:
    buffer_load_dwordx4 v[64:67], v14, s[44:47], s16 offen sc1
    buffer_load_dwordx4 v[68:71], v14, s[44:47], s17 offen sc1
    buffer_load_dwordx4 v[72:75], v14, s[44:47], s18 offen sc1
    buffer_load_dwordx4 v[76:79], v14, s[44:47], s19 offen sc1
    buffer_load_dwordx4 v[80:83], v14, s[44:47], s20 offen sc1
    buffer_load_dwordx4 v[84:87], v14, s[44:47], s21 offen sc1
    buffer_load_dwordx4 v[88:91], v14, s[44:47], s22 offen sc1
    buffer_load_dwordx4 v[92:95], v14, s[44:47], s23 offen sc1
    v_mov_b32 v15, s27
    s_waitcnt vmcnt(7)
    v_xor_b32 v64, v64, v48
    v_xor_b32 v65, v65, v49
    v_xor_b32 v66, v66, v50
    v_xor_b32 v67, v67, v51
    v_bitop3_b32 v15, v15, v64, v65 bitop3:0x80
    v_bitop3_b32 v15, v15, v66, v67 bitop3:0x80
    v_mfma_f32_16x16x32_bf16 v[100:103], v[54:57], v[64:67], v[24:27]
    v_mfma_f32_16x16x32_bf16 v[104:107], v[52:55], v[64:67], v[28:31]
    s_waitcnt vmcnt(6)
    v_xor_b32 v68, v68, v48
    v_xor_b32 v69, v69, v49
    v_xor_b32 v70, v70, v50
    v_xor_b32 v71, v71, v51
    v_bitop3_b32 v15, v15, v68, v69 bitop3:0x80
    v_bitop3_b32 v15, v15, v70, v71 bitop3:0x80
    v_mfma_f32_16x16x32_bf16 v[100:103], v[54:57], v[68:71], v[100:103]
    v_mfma_f32_16x16x32_bf16 v[104:107], v[52:55], v[68:71], v[104:107]
    s_waitcnt vmcnt(5)
    v_xor_b32 v72, v72, v48
    v_xor_b32 v73, v73, v49
    v_xor_b32 v74, v74, v50
    v_xor_b32 v75, v75, v51
    v_bitop3_b32 v15, v15, v72, v73 bitop3:0x80
    v_bitop3_b32 v15, v15, v74, v75 bitop3:0x80
    v_mfma_f32_16x16x32_bf16 v[100:103], v[54:57], v[72:75], v[100:103]
    v_mfma_f32_16x16x32_bf16 v[104:107], v[52:55], v[72:75], v[104:107]
    s_waitcnt vmcnt(4)
    v_xor_b32 v76, v76, v48
    v_xor_b32 v77, v77, v49
    v_xor_b32 v78, v78, v50
    v_xor_b32 v79, v79, v51
    v_bitop3_b32 v15, v15, v76, v77 bitop3:0x80
    v_bitop3_b32 v15, v15, v78, v79 bitop3:0x80
    v_mfma_f32_16x16x32_bf16 v[100:103], v[54:57], v[76:79], v[100:103]
    v_mfma_f32_16x16x32_bf16 v[104:107], v[52:55], v[76:79], v[104:107]
    s_waitcnt vmcnt(3)
    v_xor_b32 v80, v80, v48
    v_xor_b32 v81, v81, v49
    v_xor_b32 v82, v82, v50
    v_xor_b32 v83, v83, v51
    v_bitop3_b32 v15, v15, v80, v81 bitop3:0x80
    v_bitop3_b32 v15, v15, v82, v83 bitop3:0x80
    v_mfma_f32_16x16x32_bf16 v[100:103], v[54:57], v[80:83], v[100:103]
    v_mfma_f32_16x16x32_bf16 v[104:107], v[52:55], v[80:83], v[104:107]
    s_waitcnt vmcnt(2)
    v_xor_b32 v84, v84, v48
    v_xor_b32 v85, v85, v49
    v_xor_b32 v86, v86, v50
    v_xor_b32 v87, v87, v51
    v_bitop3_b32 v15, v15, v84, v85 bitop3:0x80
    v_bitop3_b32 v15, v15, v86, v87 bitop3:0x80
    v_mfma_f32_16x16x32_bf16 v[100:103], v[54:57], v[84:87], v[100:103]
    v_mfma_f32_16x16x32_bf16 v[104:107], v[52:55], v[84:87], v[104:107]
    s_waitcnt vmcnt(1)
    v_xor_b32 v88, v88, v48
    v_xor_b32 v89, v89, v49
    v_xor_b32 v90, v90, v50
    v_xor_b32 v91, v91, v51
    v_bitop3_b32 v15, v15, v88, v89 bitop3:0x80
    v_bitop3_b32 v15, v15, v90, v91 bitop3:0x80
    v_mfma_f32_16x16x32_bf16 v[100:103], v[54:57], v[88:91], v[100:103]
    v_mfma_f32_16x16x32_bf16 v[104:107], v[52:55], v[88:91], v[104:107]
    s_waitcnt vmcnt(0)
    v_xor_b32 v92, v92, v48
    v_xor_b32 v93, v93, v49
    v_xor_b32 v94, v94, v50
    v_xor_b32 v95, v95, v51
    v_bitop3_b32 v15, v15, v92, v93 bitop3:0x80
    v_bitop3_b32 v15, v15, v94, v95 bitop3:0x80
    v_cmp_ne_u32 vcc, s27, v15
    v_mfma_f32_16x16x32_bf16 v[100:103], v[54:57], v[92:95], v[100:103]
    v_mfma_f32_16x16x32_bf16 v[104:107], v[52:55], v[92:95], v[104:107]
    s_cbranch_vccnz L_slow1a
    s_nop 6
    v_cvt_pk_bf16_f32 v42, v100, v101
    v_cvt_pk_bf16_f32 v43, v102, v103
    buffer_store_dwordx2 v[42:43], v58, s[48:51], s30 offen
    v_cvt_pk_bf16_f32 v44, v104, v105
    v_cvt_pk_bf16_f32 v45, v106, v107
    buffer_store_dwordx2 v[44:45], v58, s[48:51], s31 offen
L_fx1a:
    s_endpgm
L_slow1a:
    v_bitop3_b32 v15, v64, v65, v66 bitop3:0x80
    v_bitop3_b32 v15, v15, v67, s27 bitop3:0x80
    v_cmp_ne_u32 s[32:33], s27, v15
    v_bitop3_b32 v15, v68, v69, v70 bitop3:0x80
    v_bitop3_b32 v15, v15, v71, s27 bitop3:0x80
    v_cmp_ne_u32 s[34:35], s27, v15
    v_bitop3_b32 v15, v72, v73, v74 bitop3:0x80
    v_bitop3_b32 v15, v15, v75, s27 bitop3:0x80
    v_cmp_ne_u32 s[36:37], s27, v15
    v_bitop3_b32 v15, v76, v77, v78 bitop3:0x80
    v_bitop3_b32 v15, v15, v79, s27 bitop3:0x80
    v_cmp_ne_u32 s[38:39], s27, v15
    v_bitop3_b32 v15, v80, v81, v82 bitop3:0x80
    v_bitop3_b32 v15, v15, v83, s27 bitop3:0x80
    v_cmp_ne_u32 s[56:57], s27, v15
    v_bitop3_b32 v15, v84, v85, v86 bitop3:0x80
    v_bitop3_b32 v15, v15, v87, s27 bitop3:0x80
    v_cmp_ne_u32 s[58:59], s27, v15
    v_bitop3_b32 v15, v88, v89, v90 bitop3:0x80
    v_bitop3_b32 v15, v15, v91, s27 bitop3:0x80
    v_cmp_ne_u32 s[60:61], s27, v15
    v_bitop3_b32 v15, v92, v93, v94 bitop3:0x80
    v_bitop3_b32 v15, v15, v95, s27 bitop3:0x80
    v_cmp_ne_u32 s[62:63], s27, v15
    s_mov_b32 s28, 0
    s_cmp_lg_u64 s[62:63], 0
    s_addc_u32 s28, s28, s28
    s_cmp_lg_u64 s[60:61], 0
    s_addc_u32 s28, s28, s28
    s_cmp_lg_u64 s[58:59], 0
    s_addc_u32 s28, s28, s28
    s_cmp_lg_u64 s[56:57], 0
    s_addc_u32 s28, s28, s28
    s_cmp_lg_u64 s[38:39], 0
    s_addc_u32 s28, s28, s28
    s_cmp_lg_u64 s[36:37], 0
    s_addc_u32 s28, s28, s28
    s_cmp_lg_u64 s[34:35], 0
    s_addc_u32 s28, s28, s28
    s_cmp_lg_u64 s[32:33], 0
    s_addc_u32 s28, s28, s28
    s_mov_b32 s29, s28
    s_mov_b32 s25, s28
    s_and_b32 s29, s29, s28
    s_cselect_b32 s29, s29, s28
    s_ff1_i32_b32 s10, s29
    s_mov_b32 m0, s10
    s_bitset0_b32 s29, s10
    s_movrels_b32 s3, s16
    buffer_load_dwordx4 v[108:111], v14, s[44:47], s3 offen sc1
    s_bitcmp1_b32 s25, 0
    s_cbranch_scc1 L_sk1a0
    v_mfma_f32_16x16x32_bf16 v[24:27], v[54:57], v[64:67], v[24:27]
    v_mfma_f32_16x16x32_bf16 v[28:31], v[52:55], v[64:67], v[28:31]
L_sk1a0:
    s_bitcmp1_b32 s25, 1
    s_cbranch_scc1 L_sk1a1
    v_mfma_f32_16x16x32_bf16 v[24:27], v[54:57], v[68:71], v[24:27]
    v_mfma_f32_16x16x32_bf16 v[28:31], v[52:55], v[68:71], v[28:31]
L_sk1a1:
    s_bitcmp1_b32 s25, 2
    s_cbranch_scc1 L_sk1a2
    v_mfma_f32_16x16x32_bf16 v[24:27], v[54:57], v[72:75], v[24:27]
    v_mfma_f32_16x16x32_bf16 v[28:31], v[52:55], v[72:75], v[28:31]
L_sk1a2:
    s_bitcmp1_b32 s25, 3
    s_cbranch_scc1 L_sk1a3
    v_mfma_f32_16x16x32_bf16 v[24:27], v[54:57], v[76:79], v[24:27]
    v_mfma_f32_16x16x32_bf16 v[28:31], v[52:55], v[76:79], v[28:31]
L_sk1a3:
    s_and_b32 s29, s29, s28
    s_cselect_b32 s29, s29, s28
    s_ff1_i32_b32 s11, s29
    s_mov_b32 m0, s11
    s_bitset0_b32 s29, s11
    s_movrels_b32 s3, s16
    buffer_load_dwordx4 v[112:115], v14, s[44:47], s3 offen sc1
    s_bitcmp1_b32 s25, 4
    s_cbranch_scc1 L_sk1a4
    v_mfma_f32_16x16x32_bf16 v[24:27], v[54:57], v[80:83], v[24:27]
    v_mfma_f32_16x16x32_bf16 v[28:31], v[52:55], v[80:83], v[28:31]
L_sk1a4:
    s_bitcmp1_b32 s25, 5
    s_cbranch_scc1 L_sk1a5
    v_mfma_f32_16x16x32_bf16 v[24:27], v[54:57], v[84:87], v[24:27]
    v_mfma_f32_16x16x32_bf16 v[28:31], v[52:55], v[84:87], v[28:31]
L_sk1a5:
    s_bitcmp1_b32 s25, 6
    s_cbranch_scc1 L_sk1a6
    v_mfma_f32_16x16x32_bf16 v[24:27], v[54:57], v[88:91], v[24:27]
    v_mfma_f32_16x16x32_bf16 v[28:31], v[52:55], v[88:91], v[28:31]
L_sk1a6:
    s_bitcmp1_b32 s25, 7
    s_cbranch_scc1 L_sk1a7
    v_mfma_f32_16x16x32_bf16 v[24:27], v[54:57], v[92:95], v[24:27]
    v_mfma_f32_16x16x32_bf16 v[28:31], v[52:55], v[92:95], v[28:31]
L_sk1a7:
    s_and_b32 s29, s29, s28
    s_cselect_b32 s29, s29, s28
    s_ff1_i32_b32 s12, s29
    s_mov_b32 m0, s12
    s_bitset0_b32 s29, s12
    s_movrels_b32 s3, s16
    buffer_load_dwordx4 v[116:119], v14, s[44:47], s3 offen sc1
L_pp1a:
    s_sleep 1
    s_and_b32 s29, s29, s28
    s_cselect_b32 s29, s29, s28
    s_ff1_i32_b32 s13, s29
    s_mov_b32 m0, s13
    s_bitset0_b32 s29, s13
    s_movrels_b32 s3, s16
    buffer_load_dwordx4 v[120:123], v14, s[44:47], s3 offen sc1
    s_waitcnt vmcnt(3)
    v_xor_b32 v108, v108, v48
    v_xor_b32 v109, v109, v49
    v_xor_b32 v110, v110, v50
    v_xor_b32 v111, v111, v51
    v_bitop3_b32 v15, v108, v109, v110 bitop3:0x80
    v_bitop3_b32 v15, v15, v111, s27 bitop3:0x80
    v_cmp_ne_u32 vcc, s27, v15
    s_bitcmp0_b32 s28, s10
    s_cbranch_scc1 L_pn1a3
    s_cbranch_vccnz L_pn1a3
    v_mfma_f32_16x16x32_bf16 v[24:27], v[54:57], v[108:111], v[24:27]
    v_mfma_f32_16x16x32_bf16 v[28:31], v[52:55], v[108:111], v[28:31]
    s_bitset0_b32 s28, s10
    s_cmp_eq_u32 s28, 0
    s_cbranch_scc1 L_pok1a
L_pn1a3:
    s_sleep 1
    s_and_b32 s29, s29, s28
    s_cselect_b32 s29, s29, s28
    s_ff1_i32_b32 s10, s29
    s_mov_b32 m0, s10
    s_bitset0_b32 s29, s10
    s_movrels_b32 s3, s16
    buffer_load_dwordx4 v[108:111], v14, s[44:47], s3 offen sc1
    s_waitcnt vmcnt(3)
    v_xor_b32 v112, v112, v48
    v_xor_b32 v113, v113, v49
    v_xor_b32 v114, v114, v50
    v_xor_b32 v115, v115, v51
    v_bitop3_b32 v15, v112, v113, v114 bitop3:0x80
    v_bitop3_b32 v15, v15, v115, s27 bitop3:0x80
    v_cmp_ne_u32 vcc, s27, v15
    s_bitcmp0_b32 s28, s11
    s_cbranch_scc1 L_pn1a0
    s_cbranch_vccnz L_pn1a0
    v_mfma_f32_16x16x32_bf16 v[24:27], v[54:57], v[112:115], v[24:27]
    v_mfma_f32_16x16x32_bf16 v[28:31], v[52:55], v[112:115], v[28:31]
    s_bitset0_b32 s28, s11
    s_cmp_eq_u32 s28, 0
    s_cbranch_scc1 L_pok1a
L_pn1a0:
    s_sleep 1
    s_and_b32 s29, s29, s28
    s_cselect_b32 s29, s29, s28
    s_ff1_i32_b32 s11, s29
    s_mov_b32 m0, s11
    s_bitset0_b32 s29, s11
    s_movrels_b32 s3, s16
    buffer_load_dwordx4 v[112:115], v14, s[44:47], s3 offen sc1
    s_waitcnt vmcnt(3)
    v_xor_b32 v116, v116, v48
    v_xor_b32 v117, v117, v49
    v_xor_b32 v118, v118, v50
    v_xor_b32 v119, v119, v51
    v_bitop3_b32 v15, v116, v117, v118 bitop3:0x80
    v_bitop3_b32 v15, v15, v119, s27 bitop3:0x80
    v_cmp_ne_u32 vcc, s27, v15
    s_bitcmp0_b32 s28, s12
    s_cbranch_scc1 L_pn1a1
    s_cbranch_vccnz L_pn1a1
    v_mfma_f32_16x16x32_bf16 v[24:27], v[54:57], v[116:119], v[24:27]
    v_mfma_f32_16x16x32_bf16 v[28:31], v[52:55], v[116:119], v[28:31]
    s_bitset0_b32 s28, s12
    s_cmp_eq_u32 s28, 0
    s_cbranch_scc1 L_pok1a
L_pn1a1:
    s_sleep 1
    s_and_b32 s29, s29, s28
    s_cselect_b32 s29, s29, s28
    s_ff1_i32_b32 s12, s29
    s_mov_b32 m0, s12
    s_bitset0_b32 s29, s12
    s_movrels_b32 s3, s16
    buffer_load_dwordx4 v[116:119], v14, s[44:47], s3 offen sc1
    s_waitcnt vmcnt(3)
    v_xor_b32 v120, v120, v48
    v_xor_b32 v121, v121, v49
    v_xor_b32 v122, v122, v50
    v_xor_b32 v123, v123, v51
    v_bitop3_b32 v15, v120, v121, v122 bitop3:0x80
    v_bitop3_b32 v15, v15, v123, s27 bitop3:0x80
    v_cmp_ne_u32 vcc, s27, v15
    s_bitcmp0_b32 s28, s13
    s_cbranch_scc1 L_pn1a2
    s_cbranch_vccnz L_pn1a2
    v_mfma_f32_16x16x32_bf16 v[24:27], v[54:57], v[120:123], v[24:27]
    v_mfma_f32_16x16x32_bf16 v[28:31], v[52:55], v[120:123], v[28:31]
    s_bitset0_b32 s28, s13
    s_cmp_eq_u32 s28, 0
    s_cbranch_scc1 L_pok1a
L_pn1a2:
    s_add_u32 s69, s69, 1
    s_cmp_gt_u32 s69, 262144
    s_cbranch_scc1 L_pok1a
    s_branch L_pp1a
L_pok1a:
    s_nop 7
    v_cvt_pk_bf16_f32 v42, v24, v25
    v_cvt_pk_bf16_f32 v43, v26, v27
    buffer_store_dwordx2 v[42:43], v58, s[48:51], s30 offen
    v_cvt_pk_bf16_f32 v44, v28, v29
    v_cvt_pk_bf16_f32 v45, v30, v31
    buffer_store_dwordx2 v[44:45], v58, s[48:51], s31 offen
    s_endpgm
L_seg_f1b:
L_lx1b:
    v_and_b32 v36, 15, v2
    v_lshrrev_b32 v37, 2, v36
    v_xor_b32 v37, v37, v33
    v_and_b32 v37, 1, v37
    v_and_b32 v38, 1, v2
    v_lshlrev_b32 v38, 4, v38
    v_mov_b32 v39, 0x3f80
    v_lshlrev_b32 v38, v38, v39
    v_bfe_u32 v39, v2, 1, 1
    v_lshl_or_b32 v37, v37, 1, v39
    v_mul_u32_u24 v36, 1152, v36
    v_add_u32 v58, v36, v40
    v_cmp_eq_u32 vcc, 0, v37
    v_mov_b32 v52, 0
    v_mov_b32 v56, 0
    v_cndmask_b32 v54, 0, v38, vcc
    v_cmp_eq_u32 vcc, 1, v37
    v_mov_b32 v53, 0
    v_mov_b32 v57, 0
    v_cndmask_b32 v55, 0, v38, vcc
    v_lshlrev_b32 v24, 16, v46
    v_and_b32 v25, 0xffff0000, v46
    v_lshlrev_b32 v26, 16, v47
    v_and_b32 v27, 0xffff0000, v47
    v_mov_b32 v28, v24
    v_mov_b32 v29, v25
    v_mov_b32 v30, v26
    v_mov_b32 v31, v27
    v_lshrrev_b32 v37, 5, v2
    v_mul_u32_u24 v37, 2048, v37
    v_add_u32 v59, v37, v14
    v_and_b32 v64, 3, v2
    v_lshlrev_b32 v64, 3, v64
    v_lshrrev_b32 v64, v64, v41
    v_bfe_u32 v65, v64, 0, 1
    v_bfe_u32 v66, v64, 1, 1
    v_lshl_or_b32 v20, v66, 16, v65
    v_bfe_u32 v65, v64, 2, 1
    v_bfe_u32 v66, v64, 3, 1
    v_lshl_or_b32 v21, v66, 16, v65
    v_bfe_u32 v65, v64, 4, 1
    v_bfe_u32 v66, v64, 5, 1
    v_lshl_or_b32 v22, v66, 16, v65
    v_bfe_u32 v65, v64, 6, 1
    v_bfe_u32 v66, v64, 7, 1
    v_lshl_or_b32 v23, v66, 16, v65
    v_xor_b32 v48, 0x10001, v20
    v_xor_b32 v49, 0x10001, v21
    v_xor_b32 v50, 0x10001, v22
    v_xor_b32 v51, 0x10001, v23
    s_mul_i32 s3, s6, 164096
    s_mul_i32 s26, s5, 20480
    s_add_u32 s26, s26, s3
    s_add_u32 s26, s26, 23068672
    s_mov_b32 s69, 0
    s_mov_b32 s27, 0x10001
    s_cmp_eq_u32 s7, 6
    s_cselect_b32 s28, 0, 0xf
    s_lshl_b32 s3, s9, 9
    s_add_u32 s26, s26, s3
    s_add_u32 s16, s26, 512
    s_add_u32 s17, s26, 5632
    s_add_u32 s18, s26, 10752
    s_add_u32 s19, s26, 15872
    s_mul_i32 s4, s7, 5
    s_add_u32 s4, s4, s9
    s_mul_i32 s4, s4, 18432
    s_add_u32 s30, s30, s4
    s_add_u32 s30, s30, 18432
    s_waitcnt vmcnt(0)
    s_barrier
    s_cmp_eq_u32 s28, 0
    s_cbranch_scc1 L_fx1b
    s_sleep 16
    s_cmp_eq_u32 s9, 1
    s_cbranch_scc1 L_poll1b
    s_sleep 7
    s_cmp_eq_u32 s9, 2
    s_cbranch_scc1 L_poll1b
    s_sleep 0
    s_branch L_poll1b
L_t2_1b:
    s_sleep 12
    s_cmp_eq_u32 s9, 1
    s_cbranch_scc1 L_poll1b
    s_sleep 4
L_poll1b:
    buffer_load_dwordx4 v[64:67], v59, s[44:47], s16 offen sc1
    buffer_load_dwordx4 v[68:71], v59, s[44:47], s17 offen sc1
    buffer_load_dwordx4 v[72:75], v59, s[44:47], s18 offen sc1
    buffer_load_dwordx4 v[76:79], v59, s[44:47], s19 offen sc1
    v_mov_b32 v15, s27
    s_waitcnt vmcnt(3)
    v_xor_b32 v64, v64, v48
    v_xor_b32 v65, v65, v49
    v_xor_b32 v66, v66, v50
    v_xor_b32 v67, v67, v51
    v_bitop3_b32 v15, v15, v64, v65 bitop3:0x80
    v_bitop3_b32 v15, v15, v66, v67 bitop3:0x80
    v_mfma_f32_16x16x32_bf16 v[100:103], v[54:57], v[64:67], v[24:27]
    v_mfma_f32_16x16x32_bf16 v[104:107], v[52:55], v[64:67], v[28:31]
    s_waitcnt vmcnt(2)
    v_xor_b32 v68, v68, v48
    v_xor_b32 v69, v69, v49
    v_xor_b32 v70, v70, v50
    v_xor_b32 v71, v71, v51
    v_bitop3_b32 v15, v15, v68, v69 bitop3:0x80
    v_bitop3_b32 v15, v15, v70, v71 bitop3:0x80
    v_mfma_f32_16x16x32_bf16 v[100:103], v[54:57], v[68:71], v[100:103]
    v_mfma_f32_16x16x32_bf16 v[104:107], v[52:55], v[68:71], v[104:107]
    s_waitcnt vmcnt(1)
    v_xor_b32 v72, v72, v48
    v_xor_b32 v73, v73, v49
    v_xor_b32 v74, v74, v50
    v_xor_b32 v75, v75, v51
    v_bitop3_b32 v15, v15, v72, v73 bitop3:0x80
    v_bitop3_b32 v15, v15, v74, v75 bitop3:0x80
    v_mfma_f32_16x16x32_bf16 v[100:103], v[54:57], v[72:75], v[100:103]
    v_mfma_f32_16x16x32_bf16 v[104:107], v[52:55], v[72:75], v[104:107]
    s_waitcnt vmcnt(0)
    v_xor_b32 v76, v76, v48
    v_xor_b32 v77, v77, v49
    v_xor_b32 v78, v78, v50
    v_xor_b32 v79, v79, v51
    v_bitop3_b32 v15, v15, v76, v77 bitop3:0x80
    v_bitop3_b32 v15, v15, v78, v79 bitop3:0x80
    v_cmp_ne_u32 vcc, s27, v15
    v_mfma_f32_16x16x32_bf16 v[100:103], v[54:57], v[76:79], v[100:103]
    v_mfma_f32_16x16x32_bf16 v[104:107], v[52:55], v[76:79], v[104:107]
    s_cbranch_vccnz L_slow1b
    s_nop 6
    s_mov_b32 exec_lo, 0
    v_mov_b32 v100, v104
    v_mov_b32 v101, v105
    v_mov_b32 v102, v106
    v_mov_b32 v103, v107
    s_mov_b32 exec_lo, -1
    v_cvt_pk_bf16_f32 v42, v100, v101
    v_cvt_pk_bf16_f32 v43, v102, v103
    buffer_store_dwordx2 v[42:43], v58, s[48:51], s30 offen
L_fx1b:
    s_endpgm
L_slow1b:
    v_bitop3_b32 v15, v64, v65, v66 bitop3:0x80
    v_bitop3_b32 v15, v15, v67, s27 bitop3:0x80
    v_cmp_ne_u32 s[32:33], s27, v15
    v_bitop3_b32 v15, v68, v69, v70 bitop3:0x80
    v_bitop3_b32 v15, v15, v71, s27 bitop3:0x80
    v_cmp_ne_u32 s[34:35], s27, v15
    v_bitop3_b32 v15, v72, v73, v74 bitop3:0x80
    v_bitop3_b32 v15, v15, v75, s27 bitop3:0x80
    v_cmp_ne_u32 s[36:37], s27, v15
    v_bitop3_b32 v15, v76, v77, v78 bitop3:0x80
    v_bitop3_b32 v15, v15, v79, s27 bitop3:0x80
    v_cmp_ne_u32 s[38:39], s27, v15
    s_mov_b32 s28, 0
    s_cmp_lg_u64 s[38:39], 0
    s_addc_u32 s28, s28, s28
    s_cmp_lg_u64 s[36:37], 0
    s_addc_u32 s28, s28, s28
    s_cmp_lg_u64 s[34:35], 0
    s_addc_u32 s28, s28, s28
    s_cmp_lg_u64 s[32:33], 0
    s_addc_u32 s28, s28, s28
    s_mov_b32 s29, s28
    s_mov_b32 s25, s28
    s_and_b32 s29, s29, s28
    s_cselect_b32 s29, s29, s28
    s_ff1_i32_b32 s10, s29
    s_mov_b32 m0, s10
    s_bitset0_b32 s29, s10
    s_movrels_b32 s3, s16
    buffer_load_dwordx4 v[108:111], v59, s[44:47], s3 offen sc1
    s_bitcmp1_b32 s25, 0
    s_cbranch_scc1 L_sk1b0
    v_mfma_f32_16x16x32_bf16 v[24:27], v[54:57], v[64:67], v[24:27]
    v_mfma_f32_16x16x32_bf16 v[28:31], v[52:55], v[64:67], v[28:31]
L_sk1b0:
    s_bitcmp1_b32 s25, 1
    s_cbranch_scc1 L_sk1b1
    v_mfma_f32_16x16x32_bf16 v[24:27], v[54:57], v[68:71], v[24:27]
    v_mfma_f32_16x16x32_bf16 v[28:31], v[52:55], v[68:71], v[28:31]
L_sk1b1:
    s_and_b32 s29, s29, s28
    s_cselect_b32 s29, s29, s28
    s_ff1_i32_b32 s11, s29
    s_mov_b32 m0, s11
    s_bitset0_b32 s29, s11
    s_movrels_b32 s3, s16
    buffer_load_dwordx4 v[112:115], v59, s[44:47], s3 offen sc1
    s_bitcmp1_b32 s25, 2
    s_cbranch_scc1 L_sk1b2
    v_mfma_f32_16x16x32_bf16 v[24:27], v[54:57], v[72:75], v[24:27]
    v_mfma_f32_16x16x32_bf16 v[28:31], v[52:55], v[72:75], v[28:31]
L_sk1b2:
    s_bitcmp1_b32 s25, 3
    s_cbranch_scc1 L_sk1b3
    v_mfma_f32_16x16x32_bf16 v[24:27], v[54:57], v[76:79], v[24:27]
    v_mfma_f32_16x16x32_bf16 v[28:31], v[52:55], v[76:79], v[28:31]
L_sk1b3:
    s_and_b32 s29, s29, s28
    s_cselect_b32 s29, s29, s28
    s_ff1_i32_b32 s12, s29
    s_mov_b32 m0, s12
    s_bitset0_b32 s29, s12
    s_movrels_b32 s3, s16
    buffer_load_dwordx4 v[116:119], v59, s[44:47], s3 offen sc1
L_pp1b:
    s_sleep 1
    s_and_b32 s29, s29, s28
    s_cselect_b32 s29, s29, s28
    s_ff1_i32_b32 s13, s29
    s_mov_b32 m0, s13
    s_bitset0_b32 s29, s13
    s_movrels_b32 s3, s16
    buffer_load_dwordx4 v[120:123], v59, s[44:47], s3 offen sc1
    s_waitcnt vmcnt(3)
    v_xor_b32 v108, v108, v48
    v_xor_b32 v109, v109, v49
    v_xor_b32 v110, v110, v50
    v_xor_b32 v111, v111, v51
    v_bitop3_b32 v15, v108, v109, v110 bitop3:0x80
    v_bitop3_b32 v15, v15, v111, s27 bitop3:0x80
    v_cmp_ne_u32 vcc, s27, v15
    s_bitcmp0_b32 s28, s10
    s_cbranch_scc1 L_pn1b3
    s_cbranch_vccnz L_pn1b3
    v_mfma_f32_16x16x32_bf16 v[24:27], v[54:57], v[108:111], v[24:27]
    v_mfma_f32_16x16x32_bf16 v[28:31], v[52:55], v[108:111], v[28:31]
    s_bitset0_b32 s28, s10
    s_cmp_eq_u32 s28, 0
    s_cbranch_scc1 L_pok1b
L_pn1b3:
    s_sleep 1
    s_and_b32 s29, s29, s28
    s_cselect_b32 s29, s29, s28
    s_ff1_i32_b32 s10, s29
    s_mov_b32 m0, s10
    s_bitset0_b32 s29, s10
    s_movrels_b32 s3, s16
    buffer_load_dwordx4 v[108:111], v59, s[44:47], s3 offen sc1
    s_waitcnt vmcnt(3)
    v_xor_b32 v112, v112, v48
    v_xor_b32 v113, v113, v49
    v_xor_b32 v114, v114, v50
    v_xor_b32 v115, v115, v51
    v_bitop3_b32 v15, v112, v113, v114 bitop3:0x80
    v_bitop3_b32 v15, v15, v115, s27 bitop3:0x80
    v_cmp_ne_u32 vcc, s27, v15
    s_bitcmp0_b32 s28, s11
    s_cbranch_scc1 L_pn1b0
    s_cbranch_vccnz L_pn1b0
    v_mfma_f32_16x16x32_bf16 v[24:27], v[54:57], v[112:115], v[24:27]
    v_mfma_f32_16x16x32_bf16 v[28:31], v[52:55], v[112:115], v[28:31]
    s_bitset0_b32 s28, s11
    s_cmp_eq_u32 s28, 0
    s_cbranch_scc1 L_pok1b
L_pn1b0:
    s_sleep 1
    s_and_b32 s29, s29, s28
    s_cselect_b32 s29, s29, s28
    s_ff1_i32_b32 s11, s29
    s_mov_b32 m0, s11
    s_bitset0_b32 s29, s11
    s_movrels_b32 s3, s16
    buffer_load_dwordx4 v[112:115], v59, s[44:47], s3 offen sc1
    s_waitcnt vmcnt(3)
    v_xor_b32 v116, v116, v48
    v_xor_b32 v117, v117, v49
    v_xor_b32 v118, v118, v50
    v_xor_b32 v119, v119, v51
    v_bitop3_b32 v15, v116, v117, v118 bitop3:0x80
    v_bitop3_b32 v15, v15, v119, s27 bitop3:0x80
    v_cmp_ne_u32 vcc, s27, v15
    s_bitcmp0_b32 s28, s12
    s_cbranch_scc1 L_pn1b1
    s_cbranch_vccnz L_pn1b1
    v_mfma_f32_16x16x32_bf16 v[24:27], v[54:57], v[116:119], v[24:27]
    v_mfma_f32_16x16x32_bf16 v[28:31], v[52:55], v[116:119], v[28:31]
    s_bitset0_b32 s28, s12
    s_cmp_eq_u32 s28, 0
    s_cbranch_scc1 L_pok1b
L_pn1b1:
    s_sleep 1
    s_and_b32 s29, s29, s28
    s_cselect_b32 s29, s29, s28
    s_ff1_i32_b32 s12, s29
    s_mov_b32 m0, s12
    s_bitset0_b32 s29, s12
    s_movrels_b32 s3, s16
    buffer_load_dwordx4 v[116:119], v59, s[44:47], s3 offen sc1
    s_waitcnt vmcnt(3)
    v_xor_b32 v120, v120, v48
    v_xor_b32 v121, v121, v49
    v_xor_b32 v122, v122, v50
    v_xor_b32 v123, v123, v51
    v_bitop3_b32 v15, v120, v121, v122 bitop3:0x80
    v_bitop3_b32 v15, v15, v123, s27 bitop3:0x80
    v_cmp_ne_u32 vcc, s27, v15
    s_bitcmp0_b32 s28, s13
    s_cbranch_scc1 L_pn1b2
    s_cbranch_vccnz L_pn1b2
    v_mfma_f32_16x16x32_bf16 v[24:27], v[54:57], v[120:123], v[24:27]
    v_mfma_f32_16x16x32_bf16 v[28:31], v[52:55], v[120:123], v[28:31]
    s_bitset0_b32 s28, s13
    s_cmp_eq_u32 s28, 0
    s_cbranch_scc1 L_pok1b
L_pn1b2:
    s_add_u32 s69, s69, 1
    s_cmp_gt_u32 s69, 262144
    s_cbranch_scc1 L_pok1b
    s_branch L_pp1b
L_pok1b:
    s_nop 7
    s_mov_b32 exec_lo, 0
    v_mov_b32 v24, v28
    v_mov_b32 v25, v29
    v_mov_b32 v26, v30
    v_mov_b32 v27, v31
    s_mov_b32 exec_lo, -1
    v_cvt_pk_bf16_f32 v42, v24, v25
    v_cvt_pk_bf16_f32 v43, v26, v27
    buffer_store_dwordx2 v[42:43], v58, s[48:51], s30 offen
    s_endpgm
L_pgend6:
.fill (25856 - (L_pgend6 - standalone__dense_activation_squared_relu__sampling_kernel)) / 4, 4, 0xbf800000
L_seg_l2:
    s_mov_b64 s[40:41], s[22:23]
    s_mov_b32 s42, 5308416
    s_mov_b32 s43, 0x20000
    s_mov_b64 s[44:45], s[30:31]
    s_mov_b32 s46, 268435456
    s_mov_b32 s47, 0x20000
    s_mov_b64 s[60:61], s[28:29]
    s_mov_b32 s62, 256
    s_mov_b32 s63, 0x20000
    s_mov_b64 s[48:49], s[26:27]
    s_mov_b32 s50, 589824
    s_mov_b32 s51, 0x20000
    s_mov_b64 s[56:57], s[24:25]
    s_mov_b32 s58, 1152
    s_mov_b32 s59, 0x20000
    v_lshlrev_b32 v14, 4, v2
    v_add_u32 v5, v36, v37
    s_mul_i32 s65, s5, 576
    s_lshl_b32 s3, s9, 3
    s_add_u32 s65, s65, s3
    s_mul_i32 s65, s65, 1152
    s_add_u32 s65, s65, 1024
    v_lshlrev_b32 v40, 3, v33
    s_and_b32 s4, s5, 3
    s_lshl_b32 s4, s4, 5
    s_add_u32 s30, s4, 1024
    s_cmp_eq_u32 s9, 0
    s_cbranch_scc1 L_rl2a
    v_and_b32 v40, 8, v40
    v_and_or_b32 v40, v2, 32, v40
    s_and_b32 s4, s30, 32
    s_lshr_b32 s4, s4, 1
    s_sub_u32 s30, s30, s4
L_rl2a:
    s_mov_b32 s16, 8
    s_add_u32 m0, s14, 32768
    s_add_u32 s3, s15, 73728
    buffer_load_dwordx4 v3, s[32:35], s3 offen lds
    s_add_u32 m0, s14, 45056
    s_add_u32 s3, s64, 294912
    buffer_load_dwordx4 v4, s[36:39], s3 offen lds
    s_add_u32 m0, s14, 36864
    s_add_u32 s3, s15, 110592
    buffer_load_dwordx4 v3, s[32:35], s3 offen lds
    s_lshl_b32 s15, s13, 7
    s_add_u32 s15, s15, s10
    s_mul_i32 s64, s13, 589824
    s_add_u32 s64, s64, s11
    s_add_u32 s13, s13, 1
    s_cmp_eq_u32 s13, 9
    s_cselect_b32 s13, 0, s13
    s_add_u32 m0, s14, 49152
    s_nop 0
    buffer_load_dwordx4 v3, s[32:35], s15 offen lds
    s_add_u32 m0, s14, 65536
    s_nop 0
    buffer_load_dwordx4 v4, s[36:39], s64 offen lds
    s_add_u32 m0, s14, 53248
    s_add_u32 s3, s15, 36864
    s_waitcnt vmcnt(13)
    buffer_load_dwordx4 v3, s[32:35], s3 offen lds
    s_add_u32 m0, s14, 57344
    s_add_u32 s3, s15, 73728
    s_waitcnt vmcnt(13)
    buffer_load_dwordx4 v3, s[32:35], s3 offen lds
    s_add_u32 m0, s14, 69632
    s_add_u32 s3, s64, 294912
    s_waitcnt vmcnt(13)
    buffer_load_dwordx4 v4, s[36:39], s3 offen lds
    s_add_u32 m0, s14, 61440
    s_add_u32 s3, s15, 110592
    s_waitcnt vmcnt(13)
    buffer_load_dwordx4 v3, s[32:35], s3 offen lds
    s_lshl_b32 s15, s13, 7
    s_add_u32 s15, s15, s10
    s_mul_i32 s64, s13, 589824
    s_add_u32 s64, s64, s11
    s_add_u32 s13, s13, 1
    s_cmp_eq_u32 s13, 9
    s_cselect_b32 s13, 0, s13
    s_add_u32 m0, s14, 73728
    s_waitcnt vmcnt(13)
    buffer_load_dwordx4 v3, s[32:35], s15 offen lds
    s_add_u32 m0, s14, 90112
    s_waitcnt vmcnt(13)
    buffer_load_dwordx4 v4, s[36:39], s64 offen lds
    s_mul_i32 s3, s8, 2
    s_add_u32 s4, s3, 0
    s_and_b32 s17, s4, 7
    s_add_u32 s4, s3, 1
    s_and_b32 s18, s4, 7
    s_add_u32 s4, s3, 2
    s_and_b32 s19, s4, 7
    s_add_u32 s4, s3, 3
    s_and_b32 s20, s4, 7
    s_add_u32 s4, s3, 4
    s_and_b32 s21, s4, 7
    s_add_u32 s4, s3, 5
    s_and_b32 s22, s4, 7
    s_add_u32 s4, s3, 6
    s_and_b32 s23, s4, 7
    s_add_u32 s4, s3, 7
    s_and_b32 s24, s4, 7
    s_lshl_b32 s12, s8, 3
    s_lshr_b32 s4, s9, 1
    s_lshl_b32 s3, s4, 2
    s_add_u32 s12, s12, s3
    s_and_b32 s3, s9, 1
    s_lshl_b32 s4, s4, 12
    s_lshl_b32 s31, s3, 10
    s_add_u32 s31, s31, s4
    s_lshr_b32 s26, s12, 2
    s_lshl_b32 s26, s26, 1
    s_lshr_b32 s26, 37092, s26
    s_add_u32 s4, s26, 0
    s_and_b32 s4, s4, 3
    s_lshl_b32 s4, s4, 10
    v_add_u32 v6, s4, v14
    s_add_u32 s4, s26, 1
    s_and_b32 s4, s4, 3
    s_lshl_b32 s4, s4, 10
    v_add_u32 v7, s4, v14
    s_add_u32 s4, s26, 2
    s_and_b32 s4, s4, 3
    s_lshl_b32 s4, s4, 10
    v_add_u32 v8, s4, v14
    s_add_u32 s4, s26, 3
    s_and_b32 s4, s4, 3
    s_lshl_b32 s4, s4, 10
    v_add_u32 v9, s4, v14
    s_mov_b32 s27, s12
    s_mul_i32 s28, s5, 622592
    s_add_u32 s28, s28, 17367040
    s_add_u32 s29, s28, 16384
    s_add_u32 s52, s44, s28
    s_addc_u32 s53, s45, 0
    s_mov_b32 s25, 0
    s_lshl_b32 s3, s3, 5
    s_add_u32 s12, s12, s3
    s_barrier
    s_add_u32 m0, s14, 77824
    s_add_u32 s3, s15, 36864
    s_waitcnt vmcnt(13)
    buffer_load_dwordx4 v3, s[32:35], s3 offen lds
    s_add_u32 m0, s14, 81920
    s_add_u32 s3, s15, 73728
    s_waitcnt vmcnt(13)
    buffer_load_dwordx4 v3, s[32:35], s3 offen lds
    s_add_u32 m0, s14, 94208
    s_add_u32 s3, s64, 294912
    s_waitcnt vmcnt(13)
    buffer_load_dwordx4 v4, s[36:39], s3 offen lds
    s_add_u32 m0, s14, 86016
    s_add_u32 s3, s15, 110592
    s_waitcnt vmcnt(13)
    buffer_load_dwordx4 v3, s[32:35], s3 offen lds
    s_load_dword s68, s[60:61], 0
    s_lshl_b32 s12, s12, 10
    s_mul_i32 s3, s5, 622592
    s_add_u32 s12, s12, s3
    s_add_u32 s12, s12, 16777216
    s_lshl_b32 s3, s17, 16
    s_add_u32 s93, s3, s12
    s_lshl_b32 s3, s18, 16
    s_add_u32 s94, s3, s12
    s_lshl_b32 s3, s19, 16
    s_add_u32 s95, s3, s12
    s_lshl_b32 s3, s20, 16
    s_add_u32 s96, s3, s12
    s_lshl_b32 s3, s21, 16
    s_add_u32 s97, s3, s12
    s_lshl_b32 s3, s22, 16
    s_add_u32 s98, s3, s12
    s_lshl_b32 s3, s23, 16
    s_add_u32 s99, s3, s12
    s_lshl_b32 s3, s24, 16
    s_add_u32 s100, s3, s12
    s_getreg_b32 s67, hwreg(HW_REG_XCC_ID, 0, 4)
    s_lshl_b32 s67, s67, 28
    s_mov_b32 s69, 0
    buffer_load_dwordx2 v[46:47], v40, s[56:59], s30 offen
    s_waitcnt vmcnt(13)
    s_barrier
    s_lshl_b32 s15, s13, 7
    s_add_u32 s15, s15, s10
    s_mul_i32 s64, s13, 589824
    s_add_u32 s64, s64, s11
    s_add_u32 s13, s13, 1
    s_cmp_eq_u32 s13, 9
    s_cselect_b32 s13, 0, s13
    s_add_u32 m0, s14, 0
    s_nop 0
    buffer_load_dwordx4 v3, s[32:35], s15 offen lds
    s_add_u32 m0, s14, 16384
    s_waitcnt vmcnt(13)
    buffer_load_dwordx4 v4, s[36:39], s64 offen lds
    s_add_u32 m0, s14, 4096
    s_add_u32 s3, s15, 36864
    s_waitcnt vmcnt(13)
    buffer_load_dwordx4 v3, s[32:35], s3 offen lds
    s_add_u32 m0, s14, 8192
    s_add_u32 s3, s15, 73728
    s_waitcnt vmcnt(13)
    buffer_load_dwordx4 v3, s[32:35], s3 offen lds
    s_add_u32 m0, s14, 20480
    s_add_u32 s3, s64, 294912
    s_waitcnt vmcnt(13)
    buffer_load_dwordx4 v4, s[36:39], s3 offen lds
    s_add_u32 m0, s14, 12288
    s_add_u32 s3, s15, 110592
    s_waitcnt vmcnt(13)
    buffer_load_dwordx4 v3, s[32:35], s3 offen lds
    s_mul_i32 s64, s16, 73728
    s_add_u32 s64, s64, s65
    s_add_u32 m0, s14, 98304
    s_waitcnt vmcnt(13)
    buffer_load_dwordx4 v5, s[40:43], s64 offen lds
    s_barrier
    s_add_u32 m0, s14, 102400
    s_add_u32 s3, s64, 36864
    s_waitcnt vmcnt(13)
    buffer_load_dwordx4 v5, s[40:43], s3 offen lds
    s_mul_i32 s64, s17, 73728
    s_add_u32 s64, s64, s65
    s_add_u32 m0, s14, 106496
    s_waitcnt vmcnt(13)
    buffer_load_dwordx4 v5, s[40:43], s64 offen lds
    s_add_u32 m0, s14, 110592
    s_add_u32 s3, s64, 36864
    s_waitcnt vmcnt(13)
    buffer_load_dwordx4 v5, s[40:43], s3 offen lds
    s_mul_i32 s64, s18, 73728
    s_add_u32 s64, s64, s65
    s_add_u32 m0, s14, 114688
    s_waitcnt vmcnt(13)
    buffer_load_dwordx4 v5, s[40:43], s64 offen lds
    s_add_u32 m0, s14, 118784
    s_add_u32 s3, s64, 36864
    s_waitcnt vmcnt(13)
    buffer_load_dwordx4 v5, s[40:43], s3 offen lds
    s_lshl_b32 s15, s13, 7
    s_add_u32 s15, s15, s10
    s_mul_i32 s64, s13, 589824
    s_add_u32 s64, s64, s11
    s_add_u32 s13, s13, 1
    s_cmp_eq_u32 s13, 9
    s_cselect_b32 s13, 0, s13
    s_add_u32 m0, s14, 24576
    s_waitcnt vmcnt(13)
    buffer_load_dwordx4 v3, s[32:35], s15 offen lds
    s_barrier
    s_add_u32 m0, s14, 40960
    s_waitcnt vmcnt(13)
    buffer_load_dwordx4 v4, s[36:39], s64 offen lds
    s_add_u32 m0, s14, 28672
    s_add_u32 s3, s15, 36864
    s_waitcnt vmcnt(13)
    buffer_load_dwordx4 v3, s[32:35], s3 offen lds
    s_add_u32 m0, s14, 32768
    s_add_u32 s3, s15, 73728
    s_waitcnt vmcnt(13)
    buffer_load_dwordx4 v3, s[32:35], s3 offen lds
    s_add_u32 m0, s14, 45056
    s_add_u32 s3, s64, 294912
    s_waitcnt vmcnt(13)
    buffer_load_dwordx4 v4, s[36:39], s3 offen lds
    s_add_u32 m0, s14, 36864
    s_add_u32 s3, s15, 110592
    s_waitcnt vmcnt(13)
    buffer_load_dwordx4 v3, s[32:35], s3 offen lds
    s_mul_i32 s64, s19, 73728
    s_add_u32 s64, s64, s65
    s_add_u32 m0, s14, 122880
    s_waitcnt vmcnt(13)
    buffer_load_dwordx4 v5, s[40:43], s64 offen lds
    s_add_u32 m0, s14, 126976
    s_add_u32 s3, s64, 36864
    s_waitcnt vmcnt(13)
    buffer_load_dwordx4 v5, s[40:43], s3 offen lds
    s_barrier
    s_lshl_b32 s15, s13, 7
    s_add_u32 s15, s15, s10
    s_mul_i32 s64, s13, 589824
    s_add_u32 s64, s64, s11
    s_add_u32 s13, s13, 1
    s_cmp_eq_u32 s13, 9
    s_cselect_b32 s13, 0, s13
    s_add_u32 m0, s14, 49152
    s_waitcnt vmcnt(13)
    buffer_load_dwordx4 v3, s[32:35], s15 offen lds
    s_add_u32 m0, s14, 65536
    s_waitcnt vmcnt(13)
    buffer_load_dwordx4 v4, s[36:39], s64 offen lds
    s_add_u32 m0, s14, 53248
    s_add_u32 s3, s15, 36864
    s_waitcnt vmcnt(13)
    buffer_load_dwordx4 v3, s[32:35], s3 offen lds
    s_add_u32 m0, s14, 57344
    s_add_u32 s3, s15, 73728
    s_waitcnt vmcnt(13)
    buffer_load_dwordx4 v3, s[32:35], s3 offen lds
    s_add_u32 m0, s14, 69632
    s_add_u32 s3, s64, 294912
    s_waitcnt vmcnt(13)
    buffer_load_dwordx4 v4, s[36:39], s3 offen lds
    s_add_u32 m0, s14, 61440
    s_add_u32 s3, s15, 110592
    s_waitcnt vmcnt(13)
    buffer_load_dwordx4 v3, s[32:35], s3 offen lds
    s_mul_i32 s64, s20, 73728
    s_add_u32 s64, s64, s65
    s_add_u32 m0, s14, 131072
    s_waitcnt vmcnt(13)
    buffer_load_dwordx4 v5, s[40:43], s64 offen lds
    s_add_u32 m0, s14, 135168
    s_add_u32 s3, s64, 36864
    s_waitcnt vmcnt(13)
    buffer_load_dwordx4 v5, s[40:43], s3 offen lds
    s_lshl_b32 s15, s13, 7
    s_add_u32 s15, s15, s10
    s_mul_i32 s64, s13, 589824
    s_add_u32 s64, s64, s11
    s_add_u32 s13, s13, 1
    s_cmp_eq_u32 s13, 9
    s_cselect_b32 s13, 0, s13
    s_add_u32 m0, s14, 73728
    s_waitcnt vmcnt(13)
    buffer_load_dwordx4 v3, s[32:35], s15 offen lds
    s_add_u32 m0, s14, 90112
    s_waitcnt vmcnt(13)
    buffer_load_dwordx4 v4, s[36:39], s64 offen lds
    s_add_u32 m0, s14, 77824
    s_add_u32 s3, s15, 36864
    s_waitcnt vmcnt(13)
    buffer_load_dwordx4 v3, s[32:35], s3 offen lds
    s_add_u32 m0, s14, 81920
    s_add_u32 s3, s15, 73728
    s_waitcnt vmcnt(13)
    buffer_load_dwordx4 v3, s[32:35], s3 offen lds
    s_barrier
    s_add_u32 m0, s14, 94208
    s_add_u32 s3, s64, 294912
    s_waitcnt vmcnt(13)
    buffer_load_dwordx4 v4, s[36:39], s3 offen lds
    s_add_u32 m0, s14, 86016
    s_add_u32 s3, s15, 110592
    s_waitcnt vmcnt(13)
    buffer_load_dwordx4 v3, s[32:35], s3 offen lds
    s_lshl_b32 s15, s13, 7
    s_add_u32 s15, s15, s10
    s_mul_i32 s64, s13, 589824
    s_add_u32 s64, s64, s11
    s_add_u32 m0, s14, 0
    s_waitcnt vmcnt(13)
    buffer_load_dwordx4 v3, s[32:35], s15 offen lds
    s_add_u32 m0, s14, 16384
    s_waitcnt vmcnt(13)
    buffer_load_dwordx4 v4, s[36:39], s64 offen lds
    s_add_u32 m0, s14, 4096
    s_add_u32 s3, s15, 36864
    s_waitcnt vmcnt(13)
    buffer_load_dwordx4 v3, s[32:35], s3 offen lds
    s_add_u32 m0, s14, 8192
    s_add_u32 s3, s15, 73728
    s_waitcnt vmcnt(13)
    buffer_load_dwordx4 v3, s[32:35], s3 offen lds
    s_add_u32 m0, s14, 20480
    s_add_u32 s3, s64, 294912
    s_waitcnt vmcnt(13)
    buffer_load_dwordx4 v4, s[36:39], s3 offen lds
    s_add_u32 m0, s14, 12288
    s_add_u32 s3, s15, 110592
    s_waitcnt vmcnt(13)
    buffer_load_dwordx4 v3, s[32:35], s3 offen lds
    s_barrier
    s_mul_i32 s64, s21, 73728
    s_add_u32 s64, s64, s65
    s_add_u32 m0, s14, 139264
    s_waitcnt vmcnt(13)
    buffer_load_dwordx4 v5, s[40:43], s64 offen lds
    s_add_u32 m0, s14, 143360
    s_add_u32 s3, s64, 36864
    s_waitcnt vmcnt(13)
    buffer_load_dwordx4 v5, s[40:43], s3 offen lds
    s_mul_i32 s64, s22, 73728
    s_add_u32 s64, s64, s65
    s_add_u32 m0, s14, 147456
    s_waitcnt vmcnt(13)
    buffer_load_dwordx4 v5, s[40:43], s64 offen lds
    s_add_u32 m0, s14, 151552
    s_add_u32 s3, s64, 36864
    s_waitcnt vmcnt(13)
    buffer_load_dwordx4 v5, s[40:43], s3 offen lds
    s_mul_i32 s64, s23, 73728
    s_add_u32 s64, s64, s65
    s_add_u32 m0, s14, 24576
    s_waitcnt vmcnt(13)
    buffer_load_dwordx4 v5, s[40:43], s64 offen lds
    s_add_u32 m0, s14, 28672
    s_add_u32 s3, s64, 36864
    s_waitcnt vmcnt(13)
    buffer_load_dwordx4 v5, s[40:43], s3 offen lds
    s_waitcnt vmcnt(12)
    s_barrier
    s_mul_i32 s64, s24, 73728
    s_add_u32 s64, s64, s65
    s_add_u32 m0, s14, 49152
    s_nop 0
    buffer_load_dwordx4 v5, s[40:43], s64 offen lds
    s_add_u32 m0, s14, 53248
    s_add_u32 s3, s64, 36864
    buffer_load_dwordx4 v5, s[40:43], s3 offen lds
    s_waitcnt vmcnt(8)
    s_barrier
    s_and_b32 s3, s9, 1
    s_lshl_b32 s3, s3, 5
    s_add_u32 s4, s26, 0
    s_and_b32 s4, s4, 3
    s_add_u32 s4, s4, s27
    s_mul_i32 s10, s4, 52
    s_lshr_b32 s10, s10, 8
    s_mul_i32 s66, s10, 5
    s_sub_u32 s4, s4, s66
    s_cmp_lt_u32 s4, 2
    s_cselect_b32 s4, 8, 0
    s_add_u32 s10, s10, s4
    s_lshl_b32 s10, s10, 6
    s_add_u32 s10, s10, s3
    s_add_u32 s4, s26, 1
    s_and_b32 s4, s4, 3
    s_add_u32 s4, s4, s27
    s_mul_i32 s11, s4, 52
    s_lshr_b32 s11, s11, 8
    s_mul_i32 s66, s11, 5
    s_sub_u32 s4, s4, s66
    s_cmp_lt_u32 s4, 2
    s_cselect_b32 s4, 8, 0
    s_add_u32 s11, s11, s4
    s_lshl_b32 s11, s11, 6
    s_add_u32 s11, s11, s3
    s_add_u32 s4, s26, 2
    s_and_b32 s4, s4, 3
    s_add_u32 s4, s4, s27
    s_mul_i32 s13, s4, 52
    s_lshr_b32 s13, s13, 8
    s_lshl_b32 s13, s13, 6
    s_add_u32 s13, s13, s3
    s_add_u32 s4, s26, 3
    s_and_b32 s4, s4, 3
    s_add_u32 s4, s4, s27
    s_mul_i32 s15, s4, 52
    s_lshr_b32 s15, s15, 8
    s_lshl_b32 s15, s15, 6
    s_add_u32 s15, s15, s3
    s_lshl_b32 s66, s8, 3
    s_add_u32 s66, s66, 448
    s_waitcnt lgkmcnt(0)
    s_cmp_eq_u32 s68, 0
    s_cbranch_scc1 L_nr2a
L_nok2a:
    v_mov_b32 v41, s68
    s_xor_b32 s67, s67, s68
    s_mov_b64 s[68:69], 0
    s_mov_b32 s54, s67
    s_mov_b32 s55, s67
    s_mov_b64 s[32:33], 0
    s_mov_b64 s[34:35], 0
    s_mov_b64 s[36:37], 0
    s_mov_b64 s[38:39], 0
    s_mov_b64 s[56:57], 0
    s_mov_b64 s[58:59], 0
    s_mov_b64 s[60:61], 0
    s_mov_b64 s[62:63], 0
    v_and_b32 v36, 15, v2
    v_lshrrev_b32 v37, 2, v36
    v_xor_b32 v37, v37, v33
    s_cmp_eq_u32 s9, 0
    s_cselect_b32 s3, 3, 1
    v_and_b32 v37, s3, v37
    v_and_b32 v38, 1, v2
    v_lshlrev_b32 v38, 4, v38
    v_mov_b32 v39, 0x3f80
    v_lshlrev_b32 v38, v38, v39
    v_bfe_u32 v39, v2, 1, 1
    v_lshl_or_b32 v37, v37, 1, v39
    v_mul_u32_u24 v36, 1152, v36
    v_add_u32 v58, v36, v40
    v_cmp_eq_u32 vcc, 0, v37
    v_mov_b32 v52, 0
    v_mov_b32 v56, 0
    v_cndmask_b32 v54, 0, v38, vcc
    v_cmp_eq_u32 vcc, 1, v37
    v_mov_b32 v53, 0
    v_mov_b32 v57, 0
    v_cndmask_b32 v55, 0, v38, vcc
    v_lshlrev_b32 v24, 16, v46
    v_and_b32 v25, 0xffff0000, v46
    v_lshlrev_b32 v26, 16, v47
    v_and_b32 v27, 0xffff0000, v47
    v_mov_b32 v28, v24
    v_mov_b32 v29, v25
    v_mov_b32 v30, v26
    v_mov_b32 v31, v27
    v_lshrrev_b32 v37, 5, v2
    v_mul_u32_u24 v37, 2048, v37
    v_add_u32 v59, v37, v14
    v_and_b32 v64, 3, v2
    v_lshlrev_b32 v64, 3, v64
    v_lshrrev_b32 v64, v64, v41
    v_bfe_u32 v65, v64, 0, 1
    v_bfe_u32 v66, v64, 1, 1
    v_lshl_or_b32 v20, v66, 16, v65
    v_bfe_u32 v65, v64, 2, 1
    v_bfe_u32 v66, v64, 3, 1
    v_lshl_or_b32 v21, v66, 16, v65
    v_bfe_u32 v65, v64, 4, 1
    v_bfe_u32 v66, v64, 5, 1
    v_lshl_or_b32 v22, v66, 16, v65
    v_bfe_u32 v65, v64, 6, 1
    v_bfe_u32 v66, v64, 7, 1
    v_lshl_or_b32 v23, v66, 16, v65
    v_xor_b32 v48, 0x10001, v20
    v_xor_b32 v49, 0x10001, v21
    v_xor_b32 v50, 0x10001, v22
    v_xor_b32 v51, 0x10001, v23
    s_barrier
    s_and_b32 m0, s17, 6
    s_branch L_g2a_a10
L_q2a_a10:
    s_add_u32 s68, s68, 1
    s_cmp_gt_u32 s68, 15
    s_cbranch_scc1 L_c2a_a10
    s_load_dwordx8 s[32:39], s[52:53], s10
    s_load_dwordx8 s[56:63], s[52:53], s11
    s_add_u32 s52, s52, 1024
    s_addc_u32 s53, s53, 0
    s_waitcnt lgkmcnt(0)
L_g2a_a10:
    s_movrels_b64 vcc, s[32:33]
    s_cmp_lg_u64 vcc, s[54:55]
    s_cbranch_scc1 L_q2a_a10
    s_movrels_b64 vcc, s[56:57]
    s_cmp_lg_u64 vcc, s[54:55]
    s_cbranch_scc1 L_q2a_a10
    s_add_u32 m0, s31, 57344
    s_nop 0
    buffer_load_dwordx4 v6, s[44:47], s93 offen sc1 lds
    s_add_u32 m0, s31, 59392
    s_nop 0
    buffer_load_dwordx4 v7, s[44:47], s93 offen sc1 lds
    s_add_u32 m0, s31, 65536
    s_nop 0
    buffer_load_dwordx4 v6, s[44:47], s94 offen sc1 lds
    s_add_u32 m0, s31, 67584
    s_nop 0
    buffer_load_dwordx4 v7, s[44:47], s94 offen sc1 lds
    s_and_b32 m0, s19, 6
    s_branch L_g2a_a12
L_q2a_a12:
    s_add_u32 s68, s68, 1
    s_cmp_gt_u32 s68, 15
    s_cbranch_scc1 L_c2a_a12
    s_load_dwordx8 s[32:39], s[52:53], s10
    s_load_dwordx8 s[56:63], s[52:53], s11
    s_add_u32 s52, s52, 1024
    s_addc_u32 s53, s53, 0
    s_waitcnt lgkmcnt(0)
L_g2a_a12:
    s_movrels_b64 vcc, s[32:33]
    s_cmp_lg_u64 vcc, s[54:55]
    s_cbranch_scc1 L_q2a_a12
    s_movrels_b64 vcc, s[56:57]
    s_cmp_lg_u64 vcc, s[54:55]
    s_cbranch_scc1 L_q2a_a12
    s_add_u32 m0, s31, 73728
    s_nop 0
    buffer_load_dwordx4 v6, s[44:47], s95 offen sc1 lds
    s_add_u32 m0, s31, 75776
    s_nop 0
    buffer_load_dwordx4 v7, s[44:47], s95 offen sc1 lds
    s_add_u32 m0, s31, 81920
    s_waitcnt vmcnt(13)
    buffer_load_dwordx4 v6, s[44:47], s96 offen sc1 lds
    s_add_u32 m0, s31, 83968
    s_waitcnt vmcnt(13)
    buffer_load_dwordx4 v7, s[44:47], s96 offen sc1 lds
    s_branch L_seg_f2
L_pgend7:
.fill (29952 - (L_pgend7 - standalone__dense_activation_squared_relu__sampling_kernel)) / 4, 4, 0xbf800000
L_seg_c2_0:
    s_waitcnt lgkmcnt(0)
    v_mov_b32 v42, s32
    v_mov_b32 v43, s33
    v_mov_b32 v44, s48
    v_mov_b32 v45, s49
    s_mov_b32 exec_lo, 0xffff0000
    v_mov_b32 v42, s34
    v_mov_b32 v43, s35
    v_mov_b32 v44, s50
    v_mov_b32 v45, s51
    s_mov_b32 exec_lo, 0
    v_mov_b32 v42, s36
    v_mov_b32 v43, s37
    v_mov_b32 v44, s52
    v_mov_b32 v45, s53
    s_mov_b32 exec_hi, 0xffff0000
    v_mov_b32 v42, s38
    v_mov_b32 v43, s39
    v_mov_b32 v44, s54
    v_mov_b32 v45, s55
    s_mov_b64 exec, -1
    s_mov_b32 s69, 0
    v_lshlrev_b32 v24, 16, v42
    v_and_b32 v25, 0xffff0000, v42
    v_lshlrev_b32 v26, 16, v43
    v_and_b32 v27, 0xffff0000, v43
    v_lshlrev_b32 v28, 16, v44
    v_and_b32 v29, 0xffff0000, v44
    v_lshlrev_b32 v30, 16, v45
    v_and_b32 v31, 0xffff0000, v45
    s_barrier
    ds_read_b64_tr_b16 v[140:141], v48 offset:16384
    ds_read_b64_tr_b16 v[142:143], v48 offset:18432
    ds_read_b64_tr_b16 v[144:145], v49 offset:16384
    ds_read_b64_tr_b16 v[146:147], v49 offset:18432
    ds_read_b128 v[60:63], v6 offset:0
    ds_read_b128 v[64:67], v6 offset:2048
    ds_read_b128 v[68:71], v6 offset:4096
    ds_read_b128 v[72:75], v6 offset:6144
    s_waitcnt lgkmcnt(3)
    v_mfma_f32_16x16x32_bf16 v[172:175], v[140:143], v[60:63], v[24:27]
    v_mfma_f32_16x16x32_bf16 v[176:179], v[144:147], v[60:63], v[28:31]
    s_waitcnt lgkmcnt(2)
    v_mfma_f32_16x16x32_bf16 v[180:183], v[140:143], v[64:67], v[24:27]
    ds_read_b64_tr_b16 v[148:149], v48 offset:20480
    ds_read_b64_tr_b16 v[150:151], v48 offset:22528
    v_mfma_f32_16x16x32_bf16 v[184:187], v[144:147], v[64:67], v[28:31]
    ds_read_b64_tr_b16 v[152:153], v49 offset:20480
    ds_read_b64_tr_b16 v[154:155], v49 offset:22528
    s_waitcnt lgkmcnt(5)
    v_mfma_f32_16x16x32_bf16 v[188:191], v[140:143], v[68:71], v[24:27]
    ds_read_b128 v[80:83], v7 offset:0
    v_mfma_f32_16x16x32_bf16 v[192:195], v[144:147], v[68:71], v[28:31]
    ds_read_b128 v[84:87], v7 offset:2048
    s_waitcnt lgkmcnt(6)
    v_mfma_f32_16x16x32_bf16 v[196:199], v[140:143], v[72:75], v[24:27]
    ds_read_b128 v[88:91], v7 offset:4096
    v_mfma_f32_16x16x32_bf16 v[200:203], v[144:147], v[72:75], v[28:31]
    ds_read_b128 v[92:95], v7 offset:6144
    s_waitcnt lgkmcnt(0)
    s_barrier
    s_load_dword s23, s[60:61], 0
    v_mfma_f32_16x16x32_bf16 v[172:175], v[148:151], v[80:83], v[172:175]
    ds_read_b64_tr_b16 v[156:157], v48 offset:40960
    ds_read_b64_tr_b16 v[158:159], v48 offset:43008
    v_mfma_f32_16x16x32_bf16 v[176:179], v[152:155], v[80:83], v[176:179]
    ds_read_b64_tr_b16 v[160:161], v49 offset:40960
    ds_read_b64_tr_b16 v[162:163], v49 offset:43008
    v_mfma_f32_16x16x32_bf16 v[180:183], v[148:151], v[84:87], v[180:183]
    ds_read_b128 v[100:103], v6 offset:24576
    v_mfma_f32_16x16x32_bf16 v[184:187], v[152:155], v[84:87], v[184:187]
    ds_read_b128 v[104:107], v6 offset:26624
    v_mfma_f32_16x16x32_bf16 v[188:191], v[148:151], v[88:91], v[188:191]
    ds_read_b128 v[108:111], v6 offset:28672
    v_mfma_f32_16x16x32_bf16 v[192:195], v[152:155], v[88:91], v[192:195]
    ds_read_b128 v[112:115], v6 offset:30720
    v_mfma_f32_16x16x32_bf16 v[196:199], v[148:151], v[92:95], v[196:199]
    ds_read_b64_tr_b16 v[164:165], v48 offset:45056
    ds_read_b64_tr_b16 v[166:167], v48 offset:47104
    v_mfma_f32_16x16x32_bf16 v[200:203], v[152:155], v[92:95], v[200:203]
    ds_read_b64_tr_b16 v[168:169], v49 offset:45056
    ds_read_b64_tr_b16 v[170:171], v49 offset:47104
    s_waitcnt lgkmcnt(7)
    v_mfma_f32_16x16x32_bf16 v[172:175], v[156:159], v[100:103], v[172:175]
    ds_read_b128 v[120:123], v7 offset:24576
    v_mfma_f32_16x16x32_bf16 v[176:179], v[160:163], v[100:103], v[176:179]
    ds_read_b128 v[124:127], v7 offset:26624
    s_waitcnt lgkmcnt(8)
    v_mfma_f32_16x16x32_bf16 v[180:183], v[156:159], v[104:107], v[180:183]
    ds_read_b128 v[128:131], v7 offset:28672
    v_mfma_f32_16x16x32_bf16 v[184:187], v[160:163], v[104:107], v[184:187]
    ds_read_b128 v[132:135], v7 offset:30720
    s_waitcnt lgkmcnt(9)
    v_mfma_f32_16x16x32_bf16 v[188:191], v[156:159], v[108:111], v[188:191]
    v_mfma_f32_16x16x32_bf16 v[192:195], v[160:163], v[108:111], v[192:195]
    s_waitcnt lgkmcnt(8)
    v_mfma_f32_16x16x32_bf16 v[196:199], v[156:159], v[112:115], v[196:199]
    v_mfma_f32_16x16x32_bf16 v[200:203], v[160:163], v[112:115], v[200:203]
    s_waitcnt lgkmcnt(0)
    s_barrier
    v_mfma_f32_16x16x32_bf16 v[172:175], v[164:167], v[120:123], v[172:175]
    ds_read_b64_tr_b16 v[140:141], v50 offset:0
    ds_read_b64_tr_b16 v[142:143], v50 offset:2048
    v_mfma_f32_16x16x32_bf16 v[176:179], v[168:171], v[120:123], v[176:179]
    ds_read_b64_tr_b16 v[144:145], v51 offset:0
    ds_read_b64_tr_b16 v[146:147], v51 offset:2048
    v_mfma_f32_16x16x32_bf16 v[180:183], v[164:167], v[124:127], v[180:183]
    ds_read_b128 v[60:63], v6 offset:49152
    v_mfma_f32_16x16x32_bf16 v[184:187], v[168:171], v[124:127], v[184:187]
    ds_read_b128 v[64:67], v6 offset:51200
    v_mfma_f32_16x16x32_bf16 v[188:191], v[164:167], v[128:131], v[188:191]
    ds_read_b128 v[68:71], v6 offset:53248
    v_mfma_f32_16x16x32_bf16 v[192:195], v[168:171], v[128:131], v[192:195]
    ds_read_b128 v[72:75], v6 offset:55296
    v_mfma_f32_16x16x32_bf16 v[196:199], v[164:167], v[132:135], v[196:199]
    ds_read_b64_tr_b16 v[148:149], v50 offset:4096
    ds_read_b64_tr_b16 v[150:151], v50 offset:6144
    v_mfma_f32_16x16x32_bf16 v[200:203], v[168:171], v[132:135], v[200:203]
    ds_read_b64_tr_b16 v[152:153], v51 offset:4096
    ds_read_b64_tr_b16 v[154:155], v51 offset:6144
    s_waitcnt lgkmcnt(7)
    v_mfma_f32_16x16x32_bf16 v[172:175], v[140:143], v[60:63], v[172:175]
    ds_read_b128 v[80:83], v7 offset:49152
    v_mfma_f32_16x16x32_bf16 v[176:179], v[144:147], v[60:63], v[176:179]
    ds_read_b128 v[84:87], v7 offset:51200
    s_waitcnt lgkmcnt(8)
    v_mfma_f32_16x16x32_bf16 v[180:183], v[140:143], v[64:67], v[180:183]
    ds_read_b128 v[88:91], v7 offset:53248
    v_mfma_f32_16x16x32_bf16 v[184:187], v[144:147], v[64:67], v[184:187]
    ds_read_b128 v[92:95], v7 offset:55296
    s_waitcnt lgkmcnt(9)
    v_mfma_f32_16x16x32_bf16 v[188:191], v[140:143], v[68:71], v[188:191]
    v_mfma_f32_16x16x32_bf16 v[192:195], v[144:147], v[68:71], v[192:195]
    s_waitcnt lgkmcnt(8)
    v_mfma_f32_16x16x32_bf16 v[196:199], v[140:143], v[72:75], v[196:199]
    v_mfma_f32_16x16x32_bf16 v[200:203], v[144:147], v[72:75], v[200:203]
    s_waitcnt lgkmcnt(0)
    s_barrier
    v_mfma_f32_16x16x32_bf16 v[172:175], v[148:151], v[80:83], v[172:175]
    ds_read_b64_tr_b16 v[156:157], v50 offset:24576
    ds_read_b64_tr_b16 v[158:159], v50 offset:26624
    v_mfma_f32_16x16x32_bf16 v[176:179], v[152:155], v[80:83], v[176:179]
    ds_read_b64_tr_b16 v[160:161], v51 offset:24576
    ds_read_b64_tr_b16 v[162:163], v51 offset:26624
    v_mfma_f32_16x16x32_bf16 v[180:183], v[148:151], v[84:87], v[180:183]
    ds_read_b128 v[100:103], v8 offset:8192
    v_mfma_f32_16x16x32_bf16 v[184:187], v[152:155], v[84:87], v[184:187]
    ds_read_b128 v[104:107], v8 offset:10240
    v_mfma_f32_16x16x32_bf16 v[188:191], v[148:151], v[88:91], v[188:191]
    ds_read_b128 v[108:111], v8 offset:12288
    v_mfma_f32_16x16x32_bf16 v[192:195], v[152:155], v[88:91], v[192:195]
    ds_read_b128 v[112:115], v8 offset:14336
    v_mfma_f32_16x16x32_bf16 v[196:199], v[148:151], v[92:95], v[196:199]
    ds_read_b64_tr_b16 v[164:165], v50 offset:28672
    ds_read_b64_tr_b16 v[166:167], v50 offset:30720
    v_mfma_f32_16x16x32_bf16 v[200:203], v[152:155], v[92:95], v[200:203]
    ds_read_b64_tr_b16 v[168:169], v51 offset:28672
    ds_read_b64_tr_b16 v[170:171], v51 offset:30720
    s_waitcnt lgkmcnt(7)
    v_mfma_f32_16x16x32_bf16 v[172:175], v[156:159], v[100:103], v[172:175]
    ds_read_b128 v[120:123], v9 offset:8192
    v_mfma_f32_16x16x32_bf16 v[176:179], v[160:163], v[100:103], v[176:179]
    ds_read_b128 v[124:127], v9 offset:10240
    s_waitcnt lgkmcnt(8)
    v_mfma_f32_16x16x32_bf16 v[180:183], v[156:159], v[104:107], v[180:183]
    ds_read_b128 v[128:131], v9 offset:12288
    v_mfma_f32_16x16x32_bf16 v[184:187], v[160:163], v[104:107], v[184:187]
    ds_read_b128 v[132:135], v9 offset:14336
    s_waitcnt lgkmcnt(9)
    v_mfma_f32_16x16x32_bf16 v[188:191], v[156:159], v[108:111], v[188:191]
    v_mfma_f32_16x16x32_bf16 v[192:195], v[160:163], v[108:111], v[192:195]
    s_waitcnt lgkmcnt(8)
    v_mfma_f32_16x16x32_bf16 v[196:199], v[156:159], v[112:115], v[196:199]
    v_mfma_f32_16x16x32_bf16 v[200:203], v[160:163], v[112:115], v[200:203]
    s_waitcnt lgkmcnt(0)
    s_barrier
    v_mfma_f32_16x16x32_bf16 v[172:175], v[164:167], v[120:123], v[172:175]
    ds_read_b64_tr_b16 v[140:141], v48 offset:16384
    ds_read_b64_tr_b16 v[142:143], v48 offset:18432
    v_mfma_f32_16x16x32_bf16 v[176:179], v[168:171], v[120:123], v[176:179]
    ds_read_b64_tr_b16 v[144:145], v49 offset:16384
    ds_read_b64_tr_b16 v[146:147], v49 offset:18432
    v_mfma_f32_16x16x32_bf16 v[180:183], v[164:167], v[124:127], v[180:183]
    ds_read_b128 v[60:63], v6 offset:0
    v_mfma_f32_16x16x32_bf16 v[184:187], v[168:171], v[124:127], v[184:187]
    ds_read_b128 v[64:67], v6 offset:2048
    v_mfma_f32_16x16x32_bf16 v[188:191], v[164:167], v[128:131], v[188:191]
    ds_read_b128 v[68:71], v6 offset:4096
    v_mfma_f32_16x16x32_bf16 v[192:195], v[168:171], v[128:131], v[192:195]
    ds_read_b128 v[72:75], v6 offset:6144
    v_mfma_f32_16x16x32_bf16 v[196:199], v[164:167], v[132:135], v[196:199]
    ds_read_b64_tr_b16 v[148:149], v48 offset:20480
    ds_read_b64_tr_b16 v[150:151], v48 offset:22528
    v_mfma_f32_16x16x32_bf16 v[200:203], v[168:171], v[132:135], v[200:203]
    ds_read_b64_tr_b16 v[152:153], v49 offset:20480
    ds_read_b64_tr_b16 v[154:155], v49 offset:22528
    s_waitcnt lgkmcnt(7)
    v_mfma_f32_16x16x32_bf16 v[172:175], v[140:143], v[60:63], v[172:175]
    ds_read_b128 v[80:83], v7 offset:0
    v_mfma_f32_16x16x32_bf16 v[176:179], v[144:147], v[60:63], v[176:179]
    ds_read_b128 v[84:87], v7 offset:2048
    s_waitcnt lgkmcnt(8)
    v_mfma_f32_16x16x32_bf16 v[180:183], v[140:143], v[64:67], v[180:183]
    ds_read_b128 v[88:91], v7 offset:4096
    v_mfma_f32_16x16x32_bf16 v[184:187], v[144:147], v[64:67], v[184:187]
    ds_read_b128 v[92:95], v7 offset:6144
    s_waitcnt lgkmcnt(9)
    v_mfma_f32_16x16x32_bf16 v[188:191], v[140:143], v[68:71], v[188:191]
    v_mfma_f32_16x16x32_bf16 v[192:195], v[144:147], v[68:71], v[192:195]
    s_waitcnt lgkmcnt(8)
    v_mfma_f32_16x16x32_bf16 v[196:199], v[140:143], v[72:75], v[196:199]
    v_mfma_f32_16x16x32_bf16 v[200:203], v[144:147], v[72:75], v[200:203]
    s_waitcnt lgkmcnt(0)
    s_barrier
    v_mfma_f32_16x16x32_bf16 v[172:175], v[148:151], v[80:83], v[172:175]
    ds_read_b64_tr_b16 v[156:157], v48 offset:40960
    ds_read_b64_tr_b16 v[158:159], v48 offset:43008
    v_mfma_f32_16x16x32_bf16 v[176:179], v[152:155], v[80:83], v[176:179]
    ds_read_b64_tr_b16 v[160:161], v49 offset:40960
    ds_read_b64_tr_b16 v[162:163], v49 offset:43008
    v_mfma_f32_16x16x32_bf16 v[180:183], v[148:151], v[84:87], v[180:183]
    ds_read_b128 v[100:103], v6 offset:24576
    s_waitcnt vmcnt(0)
    s_cmp_eq_u32 s23, 0
    s_cbranch_scc1 L_nrc2
L_nokc2:
    s_xor_b32 s21, s21, s23
    v_mfma_f32_16x16x32_bf16 v[184:187], v[152:155], v[84:87], v[184:187]
    ds_read_b128 v[104:107], v6 offset:26624
    v_mov_b32 v16, s21
    v_mfma_f32_16x16x32_bf16 v[188:191], v[148:151], v[88:91], v[188:191]
    ds_read_b128 v[108:111], v6 offset:28672
    v_and_b32 v42, 3, v2
    v_mfma_f32_16x16x32_bf16 v[192:195], v[152:155], v[88:91], v[192:195]
    ds_read_b128 v[112:115], v6 offset:30720
    v_lshlrev_b32 v42, 3, v42
    v_mfma_f32_16x16x32_bf16 v[196:199], v[148:151], v[92:95], v[196:199]
    ds_read_b64_tr_b16 v[164:165], v48 offset:45056
    ds_read_b64_tr_b16 v[166:167], v48 offset:47104
    v_mfma_f32_16x16x32_bf16 v[200:203], v[152:155], v[92:95], v[200:203]
    ds_read_b64_tr_b16 v[168:169], v49 offset:45056
    ds_read_b64_tr_b16 v[170:171], v49 offset:47104
    s_waitcnt lgkmcnt(7)
    v_mfma_f32_16x16x32_bf16 v[172:175], v[156:159], v[100:103], v[172:175]
    ds_read_b128 v[120:123], v7 offset:24576
    v_lshrrev_b32 v42, v42, s23
    v_mfma_f32_16x16x32_bf16 v[176:179], v[160:163], v[100:103], v[176:179]
    ds_read_b128 v[124:127], v7 offset:26624
    v_bfe_u32 v43, v42, 0, 1
    s_waitcnt lgkmcnt(8)
    v_mfma_f32_16x16x32_bf16 v[180:183], v[156:159], v[104:107], v[180:183]
    ds_read_b128 v[128:131], v7 offset:28672
    v_bfe_u32 v44, v42, 1, 1
    v_mfma_f32_16x16x32_bf16 v[184:187], v[160:163], v[104:107], v[184:187]
    ds_read_b128 v[132:135], v7 offset:30720
    v_lshl_or_b32 v20, v44, 16, v43
    s_waitcnt lgkmcnt(9)
    v_mfma_f32_16x16x32_bf16 v[188:191], v[156:159], v[108:111], v[188:191]
    v_bfe_u32 v43, v42, 2, 1
    v_bfe_u32 v44, v42, 3, 1
    v_mfma_f32_16x16x32_bf16 v[192:195], v[160:163], v[108:111], v[192:195]
    v_lshl_or_b32 v21, v44, 16, v43
    v_bfe_u32 v43, v42, 4, 1
    s_waitcnt lgkmcnt(8)
    v_mfma_f32_16x16x32_bf16 v[196:199], v[156:159], v[112:115], v[196:199]
    v_bfe_u32 v44, v42, 5, 1
    v_lshl_or_b32 v22, v44, 16, v43
    v_mfma_f32_16x16x32_bf16 v[200:203], v[160:163], v[112:115], v[200:203]
    v_bfe_u32 v43, v42, 6, 1
    v_bfe_u32 v44, v42, 7, 1
    s_waitcnt lgkmcnt(0)
    s_barrier
    v_mfma_f32_16x16x32_bf16 v[172:175], v[164:167], v[120:123], v[172:175]
    ds_read_b64_tr_b16 v[140:141], v50 offset:0
    ds_read_b64_tr_b16 v[142:143], v50 offset:2048
    v_mfma_f32_16x16x32_bf16 v[176:179], v[168:171], v[120:123], v[176:179]
    ds_read_b64_tr_b16 v[144:145], v51 offset:0
    ds_read_b64_tr_b16 v[146:147], v51 offset:2048
    v_mfma_f32_16x16x32_bf16 v[180:183], v[164:167], v[124:127], v[180:183]
    ds_read_b128 v[60:63], v6 offset:49152
    v_lshl_or_b32 v23, v44, 16, v43
    v_mfma_f32_16x16x32_bf16 v[184:187], v[168:171], v[124:127], v[184:187]
    ds_read_b128 v[64:67], v6 offset:51200
    v_mfma_f32_16x16x32_bf16 v[188:191], v[164:167], v[128:131], v[188:191]
    ds_read_b128 v[68:71], v6 offset:53248
    v_mfma_f32_16x16x32_bf16 v[192:195], v[168:171], v[128:131], v[192:195]
    ds_read_b128 v[72:75], v6 offset:55296
    v_mfma_f32_16x16x32_bf16 v[196:199], v[164:167], v[132:135], v[196:199]
    ds_read_b64_tr_b16 v[148:149], v50 offset:4096
    ds_read_b64_tr_b16 v[150:151], v50 offset:6144
    v_mfma_f32_16x16x32_bf16 v[200:203], v[168:171], v[132:135], v[200:203]
    ds_read_b64_tr_b16 v[152:153], v51 offset:4096
    ds_read_b64_tr_b16 v[154:155], v51 offset:6144
    s_waitcnt lgkmcnt(7)
    v_mfma_f32_16x16x32_bf16 v[172:175], v[140:143], v[60:63], v[172:175]
    ds_read_b128 v[80:83], v7 offset:49152
    v_mfma_f32_16x16x32_bf16 v[176:179], v[144:147], v[60:63], v[176:179]
    ds_read_b128 v[84:87], v7 offset:51200
    s_waitcnt lgkmcnt(8)
    v_mfma_f32_16x16x32_bf16 v[180:183], v[140:143], v[64:67], v[180:183]
    ds_read_b128 v[88:91], v7 offset:53248
    v_mfma_f32_16x16x32_bf16 v[184:187], v[144:147], v[64:67], v[184:187]
    ds_read_b128 v[92:95], v7 offset:55296
    s_waitcnt lgkmcnt(9)
    v_mfma_f32_16x16x32_bf16 v[188:191], v[140:143], v[68:71], v[188:191]
    v_mfma_f32_16x16x32_bf16 v[192:195], v[144:147], v[68:71], v[192:195]
    s_waitcnt lgkmcnt(8)
    v_mfma_f32_16x16x32_bf16 v[196:199], v[140:143], v[72:75], v[196:199]
    v_mfma_f32_16x16x32_bf16 v[200:203], v[144:147], v[72:75], v[200:203]
    s_waitcnt lgkmcnt(0)
    s_barrier
    v_mfma_f32_16x16x32_bf16 v[172:175], v[148:151], v[80:83], v[172:175]
    ds_read_b64_tr_b16 v[156:157], v50 offset:24576
    ds_read_b64_tr_b16 v[158:159], v50 offset:26624
    v_mfma_f32_16x16x32_bf16 v[176:179], v[152:155], v[80:83], v[176:179]
    ds_read_b64_tr_b16 v[160:161], v51 offset:24576
    ds_read_b64_tr_b16 v[162:163], v51 offset:26624
    v_mfma_f32_16x16x32_bf16 v[180:183], v[148:151], v[84:87], v[180:183]
    ds_read_b128 v[100:103], v8 offset:8192
    v_mfma_f32_16x16x32_bf16 v[184:187], v[152:155], v[84:87], v[184:187]
    ds_read_b128 v[104:107], v8 offset:10240
    v_mfma_f32_16x16x32_bf16 v[188:191], v[148:151], v[88:91], v[188:191]
    ds_read_b128 v[108:111], v8 offset:12288
    v_mfma_f32_16x16x32_bf16 v[192:195], v[152:155], v[88:91], v[192:195]
    ds_read_b128 v[112:115], v8 offset:14336
    v_mfma_f32_16x16x32_bf16 v[196:199], v[148:151], v[92:95], v[196:199]
    ds_read_b64_tr_b16 v[164:165], v50 offset:28672
    ds_read_b64_tr_b16 v[166:167], v50 offset:30720
    v_mfma_f32_16x16x32_bf16 v[200:203], v[152:155], v[92:95], v[200:203]
    ds_read_b64_tr_b16 v[168:169], v51 offset:28672
    ds_read_b64_tr_b16 v[170:171], v51 offset:30720
    s_waitcnt lgkmcnt(7)
    v_mfma_f32_16x16x32_bf16 v[172:175], v[156:159], v[100:103], v[172:175]
    ds_read_b128 v[120:123], v9 offset:8192
    v_mfma_f32_16x16x32_bf16 v[176:179], v[160:163], v[100:103], v[176:179]
    ds_read_b128 v[124:127], v9 offset:10240
    s_waitcnt lgkmcnt(8)
    v_mfma_f32_16x16x32_bf16 v[180:183], v[156:159], v[104:107], v[180:183]
    ds_read_b128 v[128:131], v9 offset:12288
    v_mfma_f32_16x16x32_bf16 v[184:187], v[160:163], v[104:107], v[184:187]
    ds_read_b128 v[132:135], v9 offset:14336
    s_waitcnt lgkmcnt(9)
    v_mfma_f32_16x16x32_bf16 v[188:191], v[156:159], v[108:111], v[188:191]
    v_mfma_f32_16x16x32_bf16 v[192:195], v[160:163], v[108:111], v[192:195]
    s_waitcnt lgkmcnt(8)
    v_mfma_f32_16x16x32_bf16 v[196:199], v[156:159], v[112:115], v[196:199]
    v_mfma_f32_16x16x32_bf16 v[200:203], v[160:163], v[112:115], v[200:203]
    s_waitcnt lgkmcnt(0)
    s_barrier
    v_mfma_f32_16x16x32_bf16 v[172:175], v[164:167], v[120:123], v[172:175]
    ds_read_b64_tr_b16 v[140:141], v48 offset:16384
    ds_read_b64_tr_b16 v[142:143], v48 offset:18432
    v_mfma_f32_16x16x32_bf16 v[176:179], v[168:171], v[120:123], v[176:179]
    ds_read_b64_tr_b16 v[144:145], v49 offset:16384
    ds_read_b64_tr_b16 v[146:147], v49 offset:18432
    v_mfma_f32_16x16x32_bf16 v[180:183], v[164:167], v[124:127], v[180:183]
    ds_read_b128 v[60:63], v6 offset:0
    v_mfma_f32_16x16x32_bf16 v[184:187], v[168:171], v[124:127], v[184:187]
    ds_read_b64_tr_b16 v[148:149], v48 offset:20480
    ds_read_b64_tr_b16 v[150:151], v48 offset:22528
    v_mfma_f32_16x16x32_bf16 v[188:191], v[164:167], v[128:131], v[188:191]
    ds_read_b64_tr_b16 v[152:153], v49 offset:20480
    ds_read_b64_tr_b16 v[154:155], v49 offset:22528
    v_mfma_f32_16x16x32_bf16 v[192:195], v[168:171], v[128:131], v[192:195]
    ds_read_b128 v[80:83], v7 offset:0
    v_mfma_f32_16x16x32_bf16 v[196:199], v[164:167], v[132:135], v[196:199]
    ds_read_b128 v[64:67], v6 offset:2048
    v_mfma_f32_16x16x32_bf16 v[200:203], v[168:171], v[132:135], v[200:203]
    ds_read_b128 v[84:87], v7 offset:2048
    s_waitcnt lgkmcnt(7)
    v_mfma_f32_16x16x32_bf16 v[172:175], v[140:143], v[60:63], v[172:175]
    ds_read_b128 v[68:71], v6 offset:4096
    v_mfma_f32_16x16x32_bf16 v[176:179], v[144:147], v[60:63], v[176:179]
    ds_read_b128 v[88:91], v7 offset:4096
    s_waitcnt lgkmcnt(4)
    v_mfma_f32_16x16x32_bf16 v[172:175], v[148:151], v[80:83], v[172:175]
    ds_read_b128 v[72:75], v6 offset:6144
    v_mfma_f32_16x16x32_bf16 v[176:179], v[152:155], v[80:83], v[176:179]
    ds_read_b128 v[92:95], v7 offset:6144
    s_waitcnt lgkmcnt(5)
    v_mfma_f32_16x16x32_bf16 v[180:183], v[140:143], v[64:67], v[180:183]
    v_mfma_f32_16x16x32_bf16 v[184:187], v[144:147], v[64:67], v[184:187]
    s_waitcnt lgkmcnt(4)
    v_mfma_f32_16x16x32_bf16 v[180:183], v[148:151], v[84:87], v[180:183]
    v_max_f32 v32, 0, v172
    v_max_f32 v33, 0, v173
    v_mfma_f32_16x16x32_bf16 v[184:187], v[152:155], v[84:87], v[184:187]
    v_max_f32 v34, 0, v174
    v_max_f32 v35, 0, v175
    s_waitcnt lgkmcnt(3)
    v_mfma_f32_16x16x32_bf16 v[188:191], v[140:143], v[68:71], v[188:191]
    v_pk_mul_f32 v[32:33], v[32:33], v[32:33]
    v_pk_mul_f32 v[34:35], v[34:35], v[34:35]
    v_mfma_f32_16x16x32_bf16 v[192:195], v[144:147], v[68:71], v[192:195]
    v_max_f32 v36, 0, v176
    v_max_f32 v37, 0, v177
    s_waitcnt lgkmcnt(2)
    v_mfma_f32_16x16x32_bf16 v[188:191], v[148:151], v[88:91], v[188:191]
    v_max_f32 v38, 0, v178
    v_max_f32 v39, 0, v179
    v_mfma_f32_16x16x32_bf16 v[192:195], v[152:155], v[88:91], v[192:195]
    v_pk_mul_f32 v[36:37], v[36:37], v[36:37]
    v_pk_mul_f32 v[38:39], v[38:39], v[38:39]
    s_waitcnt lgkmcnt(1)
    v_mfma_f32_16x16x32_bf16 v[196:199], v[140:143], v[72:75], v[196:199]
    v_cvt_pk_bf16_f32 v232, v32, v33
    v_cvt_pk_bf16_f32 v233, v34, v35
    v_mfma_f32_16x16x32_bf16 v[200:203], v[144:147], v[72:75], v[200:203]
    v_cvt_pk_bf16_f32 v234, v36, v37
    v_cvt_pk_bf16_f32 v235, v38, v39
    s_waitcnt lgkmcnt(0)
    v_mfma_f32_16x16x32_bf16 v[196:199], v[148:151], v[92:95], v[196:199]
    buffer_store_dwordx4 v[232:235], v14, s[44:47], s11 offen offset:0 sc1
    v_max_f32 v40, 0, v180
    v_mfma_f32_16x16x32_bf16 v[200:203], v[152:155], v[92:95], v[200:203]
    v_max_f32 v41, 0, v181
    v_max_f32 v42, 0, v182
    v_max_f32 v43, 0, v183
    v_pk_mul_f32 v[40:41], v[40:41], v[40:41]
    v_pk_mul_f32 v[42:43], v[42:43], v[42:43]
    v_max_f32 v44, 0, v184
    v_max_f32 v45, 0, v185
    v_max_f32 v46, 0, v186
    v_max_f32 v47, 0, v187
    v_pk_mul_f32 v[44:45], v[44:45], v[44:45]
    v_pk_mul_f32 v[46:47], v[46:47], v[46:47]
    v_cvt_pk_bf16_f32 v236, v40, v41
    v_cvt_pk_bf16_f32 v237, v42, v43
    v_cvt_pk_bf16_f32 v238, v44, v45
    v_cvt_pk_bf16_f32 v239, v46, v47
    buffer_store_dwordx4 v[236:239], v14, s[44:47], s11 offen offset:1024 sc1
    v_max_f32 v32, 0, v188
    v_max_f32 v33, 0, v189
    v_max_f32 v34, 0, v190
    v_max_f32 v35, 0, v191
    v_pk_mul_f32 v[32:33], v[32:33], v[32:33]
    v_pk_mul_f32 v[34:35], v[34:35], v[34:35]
    v_max_f32 v36, 0, v192
    v_max_f32 v37, 0, v193
    v_max_f32 v38, 0, v194
    v_max_f32 v39, 0, v195
    v_pk_mul_f32 v[36:37], v[36:37], v[36:37]
    v_pk_mul_f32 v[38:39], v[38:39], v[38:39]
    v_cvt_pk_bf16_f32 v240, v32, v33
    v_cvt_pk_bf16_f32 v241, v34, v35
    v_cvt_pk_bf16_f32 v242, v36, v37
    v_cvt_pk_bf16_f32 v243, v38, v39
    buffer_store_dwordx4 v[240:243], v14, s[44:47], s11 offen offset:2048 sc1
    v_max_f32 v40, 0, v196
    v_max_f32 v41, 0, v197
    v_max_f32 v42, 0, v198
    v_max_f32 v43, 0, v199
    v_pk_mul_f32 v[40:41], v[40:41], v[40:41]
    v_pk_mul_f32 v[42:43], v[42:43], v[42:43]
    v_max_f32 v44, 0, v200
    v_max_f32 v45, 0, v201
    v_max_f32 v46, 0, v202
    v_max_f32 v47, 0, v203
    v_pk_mul_f32 v[44:45], v[44:45], v[44:45]
    v_pk_mul_f32 v[46:47], v[46:47], v[46:47]
    v_cvt_pk_bf16_f32 v244, v40, v41
    v_cvt_pk_bf16_f32 v245, v42, v43
    v_cvt_pk_bf16_f32 v246, v44, v45
    v_cvt_pk_bf16_f32 v247, v46, v47
    buffer_store_dwordx4 v[244:247], v14, s[44:47], s11 offen offset:3072 sc1
    ds_write_b128 v15, v[232:235]
    ds_write_b128 v12, v[236:239]
    ds_write_b128 v13, v[240:243]
    ds_write_b128 v3, v[244:247]
    s_waitcnt lgkmcnt(0)
    s_barrier
    ds_read_b64_tr_b16 v[60:61], v50 offset:32768
    ds_read_b64_tr_b16 v[62:63], v50 offset:34816
    ds_read_b64_tr_b16 v[64:65], v51 offset:32768
    ds_read_b64_tr_b16 v[66:67], v51 offset:34816
    ds_read_b128 v[68:71], v54 offset:32768
    ds_read_b128 v[72:75], v54 offset:34816
    s_waitcnt lgkmcnt(1)
    v_mfma_f32_16x16x32_bf16 v[212:215], v[60:63], v[68:71], 0
    ds_read_b128 v[76:79], v54 offset:40960
    v_mfma_f32_16x16x32_bf16 v[216:219], v[64:67], v[68:71], 0
    ds_read_b128 v[80:83], v54 offset:43008
    s_waitcnt lgkmcnt(2)
    v_mfma_f32_16x16x32_bf16 v[220:223], v[60:63], v[72:75], 0
    ds_read_b64_tr_b16 v[84:85], v50 offset:36864
    ds_read_b64_tr_b16 v[86:87], v50 offset:38912
    v_mfma_f32_16x16x32_bf16 v[224:227], v[64:67], v[72:75], 0
    ds_read_b64_tr_b16 v[88:89], v51 offset:36864
    s_waitcnt lgkmcnt(4)
    v_mfma_f32_16x16x32_bf16 v[228:231], v[60:63], v[76:79], 0
    ds_read_b64_tr_b16 v[90:91], v51 offset:38912
    ds_read_b128 v[92:95], v54 offset:33792
    v_mfma_f32_16x16x32_bf16 v[232:235], v[64:67], v[76:79], 0
    s_waitcnt vmcnt(0)
    s_mov_b64 exec, 32767
    buffer_store_dword v16, v17, s[44:47], s22 offen offset:0
    s_mov_b64 exec, -1
    s_barrier
    ds_read_b128 v[96:99], v54 offset:35840
    s_waitcnt lgkmcnt(6)
    v_mfma_f32_16x16x32_bf16 v[236:239], v[60:63], v[80:83], 0
    ds_read_b128 v[100:103], v54 offset:41984
    ds_read_b128 v[104:107], v54 offset:44032
    ds_read_b64_tr_b16 v[108:109], v50 offset:40960
    ds_read_b64_tr_b16 v[110:111], v50 offset:43008
    ds_read_b64_tr_b16 v[112:113], v51 offset:40960
    ds_read_b64_tr_b16 v[114:115], v51 offset:43008
    ds_read_b64_tr_b16 v[116:117], v50 offset:45056
    ds_read_b64_tr_b16 v[118:119], v50 offset:47104
    ds_read_b64_tr_b16 v[120:121], v51 offset:45056
    s_waitcnt lgkmcnt(9)
    ds_read_b64_tr_b16 v[122:123], v51 offset:47104
    ds_read_b64_tr_b16 v[124:125], v50 offset:49152
    ds_read_b64_tr_b16 v[126:127], v50 offset:51200
    ds_read_b64_tr_b16 v[128:129], v51 offset:49152
    ds_read_b64_tr_b16 v[130:131], v51 offset:51200
    ds_read_b64_tr_b16 v[132:133], v50 offset:53248
    s_waitcnt lgkmcnt(9)
    ds_read_b64_tr_b16 v[134:135], v50 offset:55296
    ds_read_b64_tr_b16 v[136:137], v51 offset:53248
    ds_read_b64_tr_b16 v[138:139], v51 offset:55296
    ds_read_b64_tr_b16 v[140:141], v50 offset:57344
    ds_read_b64_tr_b16 v[142:143], v50 offset:59392
    ds_read_b64_tr_b16 v[144:145], v51 offset:57344
    s_waitcnt lgkmcnt(9)
    ds_read_b64_tr_b16 v[146:147], v51 offset:59392
    ds_read_b64_tr_b16 v[148:149], v50 offset:61440
    ds_read_b64_tr_b16 v[150:151], v50 offset:63488
    ds_read_b64_tr_b16 v[152:153], v51 offset:61440
    ds_read_b64_tr_b16 v[154:155], v51 offset:63488
    ds_read_b64_tr_b16 v[156:157], v52 offset:0
    s_waitcnt lgkmcnt(9)
    ds_read_b64_tr_b16 v[158:159], v52 offset:2048
    ds_read_b64_tr_b16 v[160:161], v53 offset:0
    ds_read_b64_tr_b16 v[162:163], v53 offset:2048
    ds_read_b64_tr_b16 v[164:165], v52 offset:4096
    ds_read_b64_tr_b16 v[166:167], v52 offset:6144
    ds_read_b64_tr_b16 v[168:169], v53 offset:4096
    s_waitcnt lgkmcnt(9)
    ds_read_b64_tr_b16 v[170:171], v53 offset:6144
    ds_read_b64_tr_b16 v[172:173], v52 offset:8192
    ds_read_b64_tr_b16 v[174:175], v52 offset:10240
    ds_read_b64_tr_b16 v[176:177], v53 offset:8192
    ds_read_b64_tr_b16 v[178:179], v53 offset:10240
    ds_read_b64_tr_b16 v[180:181], v52 offset:12288
    s_waitcnt lgkmcnt(9)
    ds_read_b64_tr_b16 v[182:183], v52 offset:14336
    ds_read_b64_tr_b16 v[184:185], v53 offset:12288
    ds_read_b64_tr_b16 v[186:187], v53 offset:14336
    s_branch L_seg_c2_11
L_pgend8:
.fill (34048 - (L_pgend8 - standalone__dense_activation_squared_relu__sampling_kernel)) / 4, 4, 0xbf800000
L_seg_c2p:
L_comp2:
    v_lshlrev_b32 v14, 4, v2
    v_and_b32 v36, 15, v2
    v_lshrrev_b32 v37, 1, v36
    v_xor_b32 v37, v37, v33
    v_lshlrev_b32 v36, 7, v36
    v_lshl_add_u32 v6, v37, 4, v36
    v_lshrrev_b32 v36, 2, v2
    v_and_b32 v38, 3, v2
    v_lshlrev_b32 v38, 3, v38
    s_lshr_b32 s3, s9, 1
    s_lshl_b32 s3, s3, 13
    v_add_u32 v6, s3, v6
    s_lshr_b32 s3, s3, 1
    v_add_u32 v54, s3, v14
    v_bfe_u32 v37, v36, 1, 2
    v_and_b32 v39, 1, v1
    v_lshlrev_b32 v39, 1, v39
    v_xor_b32 v37, v37, v39
    v_lshl_add_u32 v39, v36, 7, v38
    v_lshl_add_u32 v48, v37, 5, v39
    v_xor_b32 v49, 32, v48
    v_xor_b32 v7, 64, v6
    v_add_u32 v8, 65536, v6
    v_add_u32 v50, 65536, v48
    v_add_u32 v9, 65536, v7
    v_add_u32 v51, 65536, v49
    v_add_u32 v55, 65536, v54
    v_add_u32 v10, 131072, v6
    v_add_u32 v52, 131072, v48
    v_add_u32 v11, 131072, v7
    v_add_u32 v53, 131072, v49
    v_add_u32 v56, 131072, v54
    v_lshlrev_b32 v40, 3, v33
    s_mul_i32 s4, s5, 1152
    s_add_u32 s4, s4, 1024
    s_and_b32 s3, s9, 1
    s_lshl_b32 s3, s3, 6
    s_add_u32 s3, s3, s4
    s_waitcnt lgkmcnt(0)
    s_mov_b64 s[60:61], s[28:29]
    s_mov_b32 s62, 256
    s_mov_b32 s63, 0x20000
    s_load_dwordx8 s[32:39], s[20:21], s3
    s_load_dwordx8 s[48:55], s[20:21], s3 offset:32
    s_mov_b64 s[44:45], s[30:31]
    s_mov_b32 s46, 268435456
    s_mov_b32 s47, 0x20000
    s_cmp_lg_u32 s9, 1
    s_cbranch_scc1 L_nt2
    s_mov_b64 s[40:41], s[22:23]
    s_mov_b32 s42, 5308416
    s_mov_b32 s43, 0x20000
    v_and_b32 v46, 1, v2
    v_mul_u32_u24 v36, 622592, v46
    v_mul_u32_u24 v37, 164096, v46
    s_mul_i32 s3, s5, 622592
    s_add_u32 s3, s3, 16777088
    v_add_u32 v36, s3, v36
    s_lshl_b32 s4, s6, 9
    s_add_u32 s3, s3, s4
    s_add_u32 s3, s3, 589696
    v_lshl_add_u32 v38, v2, 6, s3
    s_mul_i32 s3, s6, 164096
    s_add_u32 s3, s3, 23068544
    v_add_u32 v37, s3, v37
    v_cmp_gt_u32 vcc, 2, v2
    s_nop 1
    v_cndmask_b32 v36, v37, v36, vcc
    v_cmp_gt_u32 vcc, 4, v2
    s_nop 1
    v_cndmask_b32 v36, v38, v36, vcc
    s_mov_b64 exec, 0xfff
    buffer_load_dword v47, v36, s[44:47], 0 offen
    v_mul_u32_u24 v36, 662400, v46
    s_mul_i32 s3, s5, 663552
    s_mov_b64 exec, 3
    buffer_load_dword v47, v36, s[40:43], s3 offen
    s_mov_b64 exec, -1
L_nt2:
    s_and_b32 s10, s9, 1
    s_add_u32 s3, s10, 16
    s_lshl_b32 s3, s3, 5
    s_lshl_b32 s4, s8, 3
    s_add_u32 s3, s3, s4
    s_lshr_b32 s4, s9, 1
    s_lshl_b32 s4, s4, 2
    s_add_u32 s3, s3, s4
    s_lshl_b32 s10, s10, 10
    s_add_u32 s10, s10, 32768
    s_lshr_b32 s4, s3, 2
    s_and_b32 s4, s4, 7
    s_lshl_b32 s4, s4, 1
    s_lshr_b32 s13, 37092, s4
    s_sub_u32 s4, 0, s13
    s_and_b32 s14, s4, 2
    s_lshl_b32 s14, s14, 12
    s_and_b32 s4, s4, 1
    s_lshl_b32 s4, s4, 11
    s_add_u32 s4, s4, s14
    s_add_u32 s4, s4, s10
    v_add_u32 v15, s4, v54
    s_sub_u32 s4, 1, s13
    s_and_b32 s14, s4, 2
    s_lshl_b32 s14, s14, 12
    s_and_b32 s4, s4, 1
    s_lshl_b32 s4, s4, 11
    s_add_u32 s4, s4, s14
    s_add_u32 s4, s4, s10
    v_add_u32 v12, s4, v54
    s_sub_u32 s4, 2, s13
    s_and_b32 s14, s4, 2
    s_lshl_b32 s14, s14, 12
    s_and_b32 s4, s4, 1
    s_lshl_b32 s4, s4, 11
    s_add_u32 s4, s4, s14
    s_add_u32 s4, s4, s10
    v_add_u32 v13, s4, v54
    s_sub_u32 s4, 3, s13
    s_and_b32 s14, s4, 2
    s_lshl_b32 s14, s14, 12
    s_and_b32 s4, s4, 1
    s_lshl_b32 s4, s4, 11
    s_add_u32 s4, s4, s14
    s_add_u32 s4, s4, s10
    v_add_u32 v3, s4, v54
    s_lshl_b32 s3, s3, 10
    s_mul_i32 s11, s5, 622592
    s_add_u32 s11, s11, s3
    s_add_u32 s11, s11, 16777216
    s_lshl_b32 s4, s9, 1
    s_lshl_b32 s3, s9, 4
    s_add_u32 s3, s3, s5
    s_mul_i32 s16, s3, 2560
    s_mul_i32 s3, s6, 164096
    s_add_u32 s16, s16, s3
    s_add_u32 s16, s16, 23068672
    s_add_u32 s17, s16, 20480
    s_xor_b32 s18, s4, s5
    s_mov_b32 s19, 0x07060302
    s_mov_b32 s20, 0x10001
    v_lshrrev_b32 v37, 5, v2
    v_mul_u32_u24 v37, 19968, v37
    v_add_u32 v19, v37, v14
    v_lshlrev_b32 v17, 10, v2
    s_getreg_b32 s21, hwreg(HW_REG_XCC_ID, 0, 4)
    s_lshl_b32 s21, s21, 28
    s_mov_b32 s3, 112
    s_lshl_b32 s4, s8, 1
    s_add_u32 s3, s3, s4
    s_lshr_b32 s4, s9, 1
    s_add_u32 s3, s3, s4
    s_and_b32 s4, s9, 1
    s_lshl_b32 s4, s4, 3
    s_add_u32 s3, s3, s4
    s_lshl_b32 s3, s3, 2
    s_mul_i32 s22, s5, 622592
    s_add_u32 s22, s22, s3
    s_add_u32 s22, s22, 17367040
    s_branch L_seg_c2_0
L_seg_c2_11:
    s_waitcnt lgkmcnt(0)
    s_barrier
    v_mfma_f32_16x16x32_bf16 v[240:243], v[64:67], v[80:83], 0
    v_mfma_f32_16x16x32_bf16 v[212:215], v[84:87], v[92:95], v[212:215]
    ds_read_b128 v[188:191], v54 offset:57344
    v_mfma_f32_16x16x32_bf16 v[216:219], v[88:91], v[92:95], v[216:219]
    ds_read_b128 v[192:195], v54 offset:59392
    v_mfma_f32_16x16x32_bf16 v[220:223], v[84:87], v[96:99], v[220:223]
    ds_read_b128 v[196:199], v54 offset:58368
    v_mfma_f32_16x16x32_bf16 v[224:227], v[88:91], v[96:99], v[224:227]
    ds_read_b128 v[200:203], v54 offset:60416
    v_mfma_f32_16x16x32_bf16 v[228:231], v[84:87], v[100:103], v[228:231]
    ds_read_b128 v[204:207], v55 offset:0
    v_mfma_f32_16x16x32_bf16 v[232:235], v[88:91], v[100:103], v[232:235]
    ds_read_b128 v[208:211], v55 offset:2048
    v_mfma_f32_16x16x32_bf16 v[236:239], v[84:87], v[104:107], v[236:239]
    ds_read_b128 v[244:247], v55 offset:1024
    v_mfma_f32_16x16x32_bf16 v[240:243], v[88:91], v[104:107], v[240:243]
    ds_read_b128 v[248:251], v55 offset:3072
    s_waitcnt lgkmcnt(7)
    v_mfma_f32_16x16x32_bf16 v[212:215], v[108:111], v[188:191], v[212:215]
    ds_read_b64_tr_b16 v[68:69], v52 offset:16384
    ds_read_b64_tr_b16 v[70:71], v52 offset:18432
    v_mfma_f32_16x16x32_bf16 v[216:219], v[112:115], v[188:191], v[216:219]
    ds_read_b64_tr_b16 v[72:73], v53 offset:16384
    s_waitcnt lgkmcnt(9)
    v_mfma_f32_16x16x32_bf16 v[220:223], v[108:111], v[192:195], v[220:223]
    ds_read_b64_tr_b16 v[74:75], v53 offset:18432
    ds_read_b64_tr_b16 v[76:77], v52 offset:20480
    v_mfma_f32_16x16x32_bf16 v[224:227], v[112:115], v[192:195], v[224:227]
    ds_read_b64_tr_b16 v[78:79], v52 offset:22528
    s_waitcnt lgkmcnt(10)
    v_mfma_f32_16x16x32_bf16 v[212:215], v[116:119], v[196:199], v[212:215]
    ds_read_b64_tr_b16 v[80:81], v53 offset:20480
    ds_read_b64_tr_b16 v[82:83], v53 offset:22528
    v_mfma_f32_16x16x32_bf16 v[216:219], v[120:123], v[196:199], v[216:219]
    s_barrier
    ds_read_b128 v[60:63], v55 offset:8192
    v_mfma_f32_16x16x32_bf16 v[220:223], v[116:119], v[200:203], v[220:223]
    v_mfma_f32_16x16x32_bf16 v[224:227], v[120:123], v[200:203], v[224:227]
    s_waitcnt lgkmcnt(9)
    v_mfma_f32_16x16x32_bf16 v[212:215], v[124:127], v[204:207], v[212:215]
    ds_read_b128 v[64:67], v55 offset:10240
    v_mfma_f32_16x16x32_bf16 v[216:219], v[128:131], v[204:207], v[216:219]
    ds_read_b128 v[92:95], v55 offset:9216
    v_mfma_f32_16x16x32_bf16 v[220:223], v[124:127], v[208:211], v[220:223]
    ds_read_b128 v[96:99], v55 offset:11264
    v_mfma_f32_16x16x32_bf16 v[224:227], v[128:131], v[208:211], v[224:227]
    ds_read_b128 v[100:103], v55 offset:16384
    v_mfma_f32_16x16x32_bf16 v[212:215], v[132:135], v[244:247], v[212:215]
    s_waitcnt lgkmcnt(5)
    ds_read_b128 v[104:107], v55 offset:18432
    v_mfma_f32_16x16x32_bf16 v[216:219], v[136:139], v[244:247], v[216:219]
    ds_read_b128 v[84:87], v55 offset:17408
    v_mfma_f32_16x16x32_bf16 v[220:223], v[132:135], v[248:251], v[220:223]
    ds_read_b128 v[88:91], v55 offset:19456
    v_mfma_f32_16x16x32_bf16 v[224:227], v[136:139], v[248:251], v[224:227]
    ds_read_b64_tr_b16 v[188:189], v48 offset:24576
    s_waitcnt lgkmcnt(8)
    v_mfma_f32_16x16x32_bf16 v[212:215], v[140:143], v[60:63], v[212:215]
    ds_read_b64_tr_b16 v[190:191], v48 offset:26624
    ds_read_b64_tr_b16 v[192:193], v49 offset:24576
    v_mfma_f32_16x16x32_bf16 v[216:219], v[144:147], v[60:63], v[216:219]
    ds_read_b64_tr_b16 v[194:195], v49 offset:26624
    s_waitcnt lgkmcnt(9)
    v_mfma_f32_16x16x32_bf16 v[220:223], v[140:143], v[64:67], v[220:223]
    ds_read_b64_tr_b16 v[196:197], v48 offset:28672
    ds_read_b64_tr_b16 v[198:199], v48 offset:30720
    v_mfma_f32_16x16x32_bf16 v[224:227], v[144:147], v[64:67], v[224:227]
    ds_read_b64_tr_b16 v[200:201], v49 offset:28672
    ds_read_b64_tr_b16 v[202:203], v49 offset:30720
    v_mfma_f32_16x16x32_bf16 v[212:215], v[148:151], v[92:95], v[212:215]
    v_mfma_f32_16x16x32_bf16 v[216:219], v[152:155], v[92:95], v[216:219]
    s_barrier
    s_waitcnt lgkmcnt(9)
    v_mfma_f32_16x16x32_bf16 v[220:223], v[148:151], v[96:99], v[220:223]
    ds_read_b128 v[204:207], v55 offset:24576
    v_mfma_f32_16x16x32_bf16 v[224:227], v[152:155], v[96:99], v[224:227]
    ds_read_b128 v[208:211], v55 offset:26624
    v_mfma_f32_16x16x32_bf16 v[212:215], v[156:159], v[100:103], v[212:215]
    ds_read_b128 v[244:247], v55 offset:25600
    v_mfma_f32_16x16x32_bf16 v[216:219], v[160:163], v[100:103], v[216:219]
    ds_read_b128 v[248:251], v55 offset:27648
    v_mfma_f32_16x16x32_bf16 v[220:223], v[156:159], v[104:107], v[220:223]
    s_waitcnt lgkmcnt(6)
    ds_read_b128 v[60:63], v54 offset:0
    v_mfma_f32_16x16x32_bf16 v[224:227], v[160:163], v[104:107], v[224:227]
    ds_read_b128 v[64:67], v54 offset:2048
    v_mfma_f32_16x16x32_bf16 v[212:215], v[164:167], v[84:87], v[212:215]
    ds_read_b128 v[92:95], v54 offset:1024
    v_mfma_f32_16x16x32_bf16 v[216:219], v[168:171], v[84:87], v[216:219]
    ds_read_b128 v[96:99], v54 offset:3072
    v_mfma_f32_16x16x32_bf16 v[220:223], v[164:167], v[88:91], v[220:223]
    ds_read_b64_tr_b16 v[100:101], v48 offset:49152
    ds_read_b64_tr_b16 v[102:103], v48 offset:51200
    v_mfma_f32_16x16x32_bf16 v[224:227], v[168:171], v[88:91], v[224:227]
    ds_read_b64_tr_b16 v[104:105], v49 offset:49152
    s_waitcnt lgkmcnt(9)
    v_mfma_f32_16x16x32_bf16 v[212:215], v[172:175], v[204:207], v[212:215]
    ds_read_b64_tr_b16 v[106:107], v49 offset:51200
    ds_read_b64_tr_b16 v[84:85], v48 offset:53248
    v_mfma_f32_16x16x32_bf16 v[216:219], v[176:179], v[204:207], v[216:219]
    ds_read_b64_tr_b16 v[86:87], v48 offset:55296
    ds_read_b64_tr_b16 v[88:89], v49 offset:53248
    v_mfma_f32_16x16x32_bf16 v[220:223], v[172:175], v[208:211], v[220:223]
    v_mfma_f32_16x16x32_bf16 v[224:227], v[176:179], v[208:211], v[224:227]
    s_waitcnt lgkmcnt(9)
    v_mfma_f32_16x16x32_bf16 v[212:215], v[180:183], v[244:247], v[212:215]
    ds_read_b64_tr_b16 v[90:91], v49 offset:55296
    v_mfma_f32_16x16x32_bf16 v[216:219], v[184:187], v[244:247], v[216:219]
    s_barrier
    ds_read_b128 v[204:207], v54 offset:8192
    v_mfma_f32_16x16x32_bf16 v[220:223], v[180:183], v[248:251], v[220:223]
    ds_read_b128 v[208:211], v54 offset:10240
    v_mfma_f32_16x16x32_bf16 v[224:227], v[184:187], v[248:251], v[224:227]
    ds_read_b128 v[244:247], v54 offset:9216
    v_mfma_f32_16x16x32_bf16 v[212:215], v[68:71], v[60:63], v[212:215]
    s_waitcnt lgkmcnt(6)
    ds_read_b128 v[248:251], v54 offset:11264
    v_mfma_f32_16x16x32_bf16 v[216:219], v[72:75], v[60:63], v[216:219]
    ds_read_b128 v[60:63], v54 offset:16384
    v_mfma_f32_16x16x32_bf16 v[220:223], v[68:71], v[64:67], v[220:223]
    v_mfma_f32_16x16x32_bf16 v[224:227], v[72:75], v[64:67], v[224:227]
    ds_read_b128 v[64:67], v54 offset:18432
    v_mfma_f32_16x16x32_bf16 v[212:215], v[76:79], v[92:95], v[212:215]
    v_mfma_f32_16x16x32_bf16 v[216:219], v[80:83], v[92:95], v[216:219]
    ds_read_b128 v[92:95], v54 offset:17408
    v_mfma_f32_16x16x32_bf16 v[220:223], v[76:79], v[96:99], v[220:223]
    v_mfma_f32_16x16x32_bf16 v[224:227], v[80:83], v[96:99], v[224:227]
    ds_read_b128 v[96:99], v54 offset:19456
    s_waitcnt lgkmcnt(5)
    v_mfma_f32_16x16x32_bf16 v[212:215], v[188:191], v[204:207], v[212:215]
    v_mfma_f32_16x16x32_bf16 v[216:219], v[192:195], v[204:207], v[216:219]
    v_mfma_f32_16x16x32_bf16 v[220:223], v[188:191], v[208:211], v[220:223]
    v_mfma_f32_16x16x32_bf16 v[224:227], v[192:195], v[208:211], v[224:227]
    v_mfma_f32_16x16x32_bf16 v[212:215], v[196:199], v[244:247], v[212:215]
    v_mfma_f32_16x16x32_bf16 v[216:219], v[200:203], v[244:247], v[216:219]
    s_barrier
    ds_read_b128 v[204:207], v54 offset:32768
    s_waitcnt lgkmcnt(2)
    v_mfma_f32_16x16x32_bf16 v[220:223], v[196:199], v[248:251], v[220:223]
    ds_read_b128 v[208:211], v54 offset:33792
    v_mfma_f32_16x16x32_bf16 v[224:227], v[200:203], v[248:251], v[224:227]
    ds_read_b128 v[244:247], v54 offset:40960
    v_mfma_f32_16x16x32_bf16 v[212:215], v[100:103], v[60:63], v[212:215]
    ds_read_b128 v[248:251], v54 offset:41984
    v_mfma_f32_16x16x32_bf16 v[216:219], v[104:107], v[60:63], v[216:219]
    ds_read_b128 v[60:63], v55 offset:32768
    v_mfma_f32_16x16x32_bf16 v[220:223], v[100:103], v[64:67], v[220:223]
    v_mfma_f32_16x16x32_bf16 v[224:227], v[104:107], v[64:67], v[224:227]
    ds_read_b128 v[64:67], v55 offset:33792
    v_mfma_f32_16x16x32_bf16 v[212:215], v[84:87], v[92:95], v[212:215]
    v_mfma_f32_16x16x32_bf16 v[216:219], v[88:91], v[92:95], v[216:219]
    ds_read_b128 v[92:95], v55 offset:40960
    s_waitcnt lgkmcnt(6)
    v_mfma_f32_16x16x32_bf16 v[220:223], v[84:87], v[96:99], v[220:223]
    v_mfma_f32_16x16x32_bf16 v[224:227], v[88:91], v[96:99], v[224:227]
    ds_read_b128 v[96:99], v55 offset:41984
    v_mfma_f32_16x16x32_bf16 v[228:231], v[108:111], v[204:207], v[228:231]
    v_mfma_f32_16x16x32_bf16 v[232:235], v[112:115], v[204:207], v[232:235]
    ds_read_b128 v[204:207], v55 offset:49152
    s_waitcnt lgkmcnt(4)
    v_mfma_f32_16x16x32_bf16 v[228:231], v[116:119], v[208:211], v[228:231]
    v_mfma_f32_16x16x32_bf16 v[232:235], v[120:123], v[208:211], v[232:235]
    v_perm_b32 v24, v213, v212, s19
    v_perm_b32 v25, v215, v214, s19
    v_mfma_f32_16x16x32_bf16 v[228:231], v[124:127], v[244:247], v[228:231]
    v_perm_b32 v26, v221, v220, s19
    v_perm_b32 v27, v223, v222, s19
    v_mfma_f32_16x16x32_bf16 v[232:235], v[128:131], v[244:247], v[232:235]
    v_bfi_b32 v24, s20, v20, v24
    v_bfi_b32 v25, s20, v21, v25
    v_mfma_f32_16x16x32_bf16 v[228:231], v[132:135], v[248:251], v[228:231]
    v_bfi_b32 v26, s20, v22, v26
    v_bfi_b32 v27, s20, v23, v27
    v_mfma_f32_16x16x32_bf16 v[232:235], v[136:139], v[248:251], v[232:235]
    buffer_store_dwordx4 v[24:27], v14, s[44:47], s16 offen offset:0 sc1
    v_perm_b32 v28, v217, v216, s19
    v_mfma_f32_16x16x32_bf16 v[228:231], v[140:143], v[60:63], v[228:231]
    v_perm_b32 v29, v219, v218, s19
    v_perm_b32 v30, v225, v224, s19
    v_mfma_f32_16x16x32_bf16 v[232:235], v[144:147], v[60:63], v[232:235]
    v_perm_b32 v31, v227, v226, s19
    s_waitcnt lgkmcnt(0)
    v_mfma_f32_16x16x32_bf16 v[228:231], v[148:151], v[64:67], v[228:231]
    ds_read_b128 v[208:211], v55 offset:50176
    v_bfi_b32 v28, s20, v20, v28
    v_mfma_f32_16x16x32_bf16 v[232:235], v[152:155], v[64:67], v[232:235]
    v_bfi_b32 v29, s20, v21, v29
    v_bfi_b32 v30, s20, v22, v30
    v_mfma_f32_16x16x32_bf16 v[228:231], v[156:159], v[92:95], v[228:231]
    ds_read_b128 v[244:247], v55 offset:57344
    v_bfi_b32 v31, s20, v23, v31
    v_mfma_f32_16x16x32_bf16 v[232:235], v[160:163], v[92:95], v[232:235]
    buffer_store_dwordx4 v[28:31], v14, s[44:47], s17 offen offset:0 sc1
    ds_read_b128 v[248:251], v55 offset:58368
    v_mfma_f32_16x16x32_bf16 v[228:231], v[164:167], v[96:99], v[228:231]
    ds_read_b128 v[60:63], v56 offset:0
    v_mfma_f32_16x16x32_bf16 v[232:235], v[168:171], v[96:99], v[232:235]
    ds_read_b128 v[64:67], v56 offset:1024
    v_mfma_f32_16x16x32_bf16 v[228:231], v[172:175], v[204:207], v[228:231]
    ds_read_b128 v[92:95], v56 offset:8192
    v_mfma_f32_16x16x32_bf16 v[232:235], v[176:179], v[204:207], v[232:235]
    ds_read_b128 v[96:99], v56 offset:9216
    s_waitcnt lgkmcnt(6)
    v_mfma_f32_16x16x32_bf16 v[228:231], v[180:183], v[208:211], v[228:231]
    v_mfma_f32_16x16x32_bf16 v[232:235], v[184:187], v[208:211], v[232:235]
    s_waitcnt lgkmcnt(5)
    v_mfma_f32_16x16x32_bf16 v[228:231], v[68:71], v[244:247], v[228:231]
    v_mfma_f32_16x16x32_bf16 v[232:235], v[72:75], v[244:247], v[232:235]
    s_barrier
    ds_read_b128 v[204:207], v54 offset:34816
    s_waitcnt lgkmcnt(5)
    v_mfma_f32_16x16x32_bf16 v[228:231], v[76:79], v[248:251], v[228:231]
    ds_read_b128 v[208:211], v54 offset:35840
    v_mfma_f32_16x16x32_bf16 v[232:235], v[80:83], v[248:251], v[232:235]
    ds_read_b128 v[244:247], v54 offset:43008
    s_waitcnt lgkmcnt(5)
    v_mfma_f32_16x16x32_bf16 v[228:231], v[188:191], v[60:63], v[228:231]
    ds_read_b128 v[248:251], v54 offset:44032
    v_mfma_f32_16x16x32_bf16 v[232:235], v[192:195], v[60:63], v[232:235]
    ds_read_b128 v[60:63], v55 offset:34816
    v_mfma_f32_16x16x32_bf16 v[228:231], v[196:199], v[64:67], v[228:231]
    v_mfma_f32_16x16x32_bf16 v[232:235], v[200:203], v[64:67], v[232:235]
    ds_read_b128 v[64:67], v55 offset:35840
    s_waitcnt lgkmcnt(6)
    v_mfma_f32_16x16x32_bf16 v[228:231], v[100:103], v[92:95], v[228:231]
    v_mfma_f32_16x16x32_bf16 v[232:235], v[104:107], v[92:95], v[232:235]
    ds_read_b128 v[92:95], v55 offset:43008
    v_mfma_f32_16x16x32_bf16 v[228:231], v[84:87], v[96:99], v[228:231]
    v_mfma_f32_16x16x32_bf16 v[232:235], v[88:91], v[96:99], v[232:235]
    ds_read_b128 v[96:99], v55 offset:44032
    s_waitcnt lgkmcnt(5)
    v_mfma_f32_16x16x32_bf16 v[236:239], v[108:111], v[204:207], v[236:239]
    v_mfma_f32_16x16x32_bf16 v[240:243], v[112:115], v[204:207], v[240:243]
    v_mfma_f32_16x16x32_bf16 v[236:239], v[116:119], v[208:211], v[236:239]
    v_mfma_f32_16x16x32_bf16 v[240:243], v[120:123], v[208:211], v[240:243]
    v_perm_b32 v32, v229, v228, s19
    v_perm_b32 v33, v231, v230, s19
    v_mfma_f32_16x16x32_bf16 v[236:239], v[124:127], v[244:247], v[236:239]
    v_perm_b32 v34, v233, v232, s19
    v_perm_b32 v35, v235, v234, s19
    v_mfma_f32_16x16x32_bf16 v[240:243], v[128:131], v[244:247], v[240:243]
    s_barrier
    v_bfi_b32 v32, s20, v20, v32
    s_waitcnt lgkmcnt(1)
    v_mfma_f32_16x16x32_bf16 v[236:239], v[132:135], v[248:251], v[236:239]
    v_bfi_b32 v33, s20, v21, v33
    v_bfi_b32 v34, s20, v22, v34
    v_mfma_f32_16x16x32_bf16 v[240:243], v[136:139], v[248:251], v[240:243]
    v_bfi_b32 v35, s20, v23, v35
    buffer_store_dwordx4 v[32:35], v19, s[44:47], s16 offen offset:1024 sc1
    v_mfma_f32_16x16x32_bf16 v[236:239], v[140:143], v[60:63], v[236:239]
    ds_read_b128 v[204:207], v55 offset:51200
    v_mfma_f32_16x16x32_bf16 v[240:243], v[144:147], v[60:63], v[240:243]
    ds_read_b128 v[108:111], v55 offset:52224
    v_mfma_f32_16x16x32_bf16 v[236:239], v[148:151], v[64:67], v[236:239]
    ds_read_b128 v[112:115], v55 offset:59392
    v_mfma_f32_16x16x32_bf16 v[240:243], v[152:155], v[64:67], v[240:243]
    ds_read_b128 v[208:211], v55 offset:60416
    v_mfma_f32_16x16x32_bf16 v[236:239], v[156:159], v[92:95], v[236:239]
    ds_read_b128 v[116:119], v56 offset:2048
    v_mfma_f32_16x16x32_bf16 v[240:243], v[160:163], v[92:95], v[240:243]
    ds_read_b128 v[120:123], v56 offset:3072
    s_waitcnt lgkmcnt(6)
    v_mfma_f32_16x16x32_bf16 v[236:239], v[164:167], v[96:99], v[236:239]
    ds_read_b128 v[244:247], v56 offset:10240
    v_mfma_f32_16x16x32_bf16 v[240:243], v[168:171], v[96:99], v[240:243]
    ds_read_b128 v[124:127], v56 offset:11264
    s_waitcnt lgkmcnt(7)
    v_mfma_f32_16x16x32_bf16 v[236:239], v[172:175], v[204:207], v[236:239]
    v_mfma_f32_16x16x32_bf16 v[240:243], v[176:179], v[204:207], v[240:243]
    s_waitcnt lgkmcnt(6)
    v_mfma_f32_16x16x32_bf16 v[236:239], v[180:183], v[108:111], v[236:239]
    v_mfma_f32_16x16x32_bf16 v[240:243], v[184:187], v[108:111], v[240:243]
    s_waitcnt lgkmcnt(4)
    v_mfma_f32_16x16x32_bf16 v[236:239], v[68:71], v[112:115], v[236:239]
    v_mfma_f32_16x16x32_bf16 v[240:243], v[72:75], v[112:115], v[240:243]
    v_mfma_f32_16x16x32_bf16 v[236:239], v[76:79], v[208:211], v[236:239]
    v_mfma_f32_16x16x32_bf16 v[240:243], v[80:83], v[208:211], v[240:243]
    s_waitcnt lgkmcnt(0)
    v_mfma_f32_16x16x32_bf16 v[236:239], v[188:191], v[116:119], v[236:239]
    v_mfma_f32_16x16x32_bf16 v[240:243], v[192:195], v[116:119], v[240:243]
    v_mfma_f32_16x16x32_bf16 v[236:239], v[196:199], v[120:123], v[236:239]
    v_mfma_f32_16x16x32_bf16 v[240:243], v[200:203], v[120:123], v[240:243]
    v_mfma_f32_16x16x32_bf16 v[236:239], v[100:103], v[244:247], v[236:239]
    v_mfma_f32_16x16x32_bf16 v[240:243], v[104:107], v[244:247], v[240:243]
    v_mfma_f32_16x16x32_bf16 v[236:239], v[84:87], v[124:127], v[236:239]
    v_mfma_f32_16x16x32_bf16 v[240:243], v[88:91], v[124:127], v[240:243]
    s_nop 7
    v_perm_b32 v36, v237, v236, s19
    v_perm_b32 v37, v239, v238, s19
    v_perm_b32 v38, v241, v240, s19
    v_perm_b32 v39, v243, v242, s19
    v_bfi_b32 v36, s20, v20, v36
    v_bfi_b32 v37, s20, v21, v37
    v_bfi_b32 v38, s20, v22, v38
    v_bfi_b32 v39, s20, v23, v39
    buffer_store_dwordx4 v[36:39], v19, s[44:47], s16 offen offset:1536 sc1
L_cx2:
    s_endpgm
L_pgend9:
.p2align 6
L_codeend:
    s_endpgm
.section .rodata,"a"
.p2align 6
.amdhsa_kernel standalone__dense_activation_squared_relu__sampling_kernel
  .amdhsa_next_free_vgpr 256
  .amdhsa_next_free_sgpr 102
  .amdhsa_accum_offset 256
  .amdhsa_group_segment_fixed_size 0
  .amdhsa_kernarg_size 64
  .amdhsa_user_sgpr_count 2
  .amdhsa_user_sgpr_kernarg_segment_ptr 1
  .amdhsa_system_sgpr_workgroup_id_x 1
.end_amdhsa_kernel
```
